```python
import torch

def _softmax(x, axis=-1):
    return torch.softmax(x, dim=axis)
def _gelu(x):
    return torch.nn.functional.gelu(x, approximate="tanh")
def _silu(x):
    return torch.nn.functional.silu(x)
def _sigmoid(x):
    return torch.sigmoid(x)
def _layernorm(x, axis=-1, eps=1e-5):
    m = x.mean(dim=axis, keepdim=True)
    v = x.var(dim=axis, keepdim=True, unbiased=False)
    return (x - m) / torch.sqrt(v + eps)
def _scatter_add(tgt, idx, src, axis=0):
    return tgt.clone().index_add_(axis, idx, src)
def _segment_sum(src, seg, n):
    out = torch.zeros((n,) + src.shape[1:], dtype=src.dtype)
    return out.index_add_(0, seg, src)
def _pad(x, pw):
    flat = tuple(v for pair in reversed(pw) for v in pair)
    return torch.nn.functional.pad(x, flat)

kernel_name = 'sequential_preLN__gqa_block_cached__geglu_ffn__decode'

def setup_inputs():

    _w = (lambda a: (lambda t: t.to(torch.bfloat16) if t.is_floating_point() else t)(torch.as_tensor(a)))
    def _A_setup():
        B, Sq, D = 2, 1, 640
        Hq, Hkv, Sk, Dh = 32, 32, 8192, 128
        assert Hq % Hkv == 0, (Hq, Hkv)
        return {
            "x": _w((lambda *s: torch.randn(*s, dtype=torch.bfloat16) * 0.05)(B, Sq, D)),
            "k_cache": _w((lambda *s: torch.randn(*s, dtype=torch.bfloat16) * 3.2)(B, Hkv, Sk, Dh)),
            "v_cache": _w((lambda *s: torch.randn(*s, dtype=torch.bfloat16) * 0.4)(B, Hkv, Sk, Dh)),
            "wq": _w((lambda *s: torch.randn(*s, dtype=torch.bfloat16) * 3.2)(D, Hq * Dh) * (D ** -0.5)),
            "wo": _w((lambda *s: torch.randn(*s, dtype=torch.bfloat16) * 0.4)(Hq * Dh, D) * ((Hq * Dh) ** -0.5)),
        }
    _A_in = _A_setup()

    def _B_setup():
        B, S, D, F = 2, 1, 640, 1728
        return {
            "x": _w((lambda *s: torch.randn(*s, dtype=torch.bfloat16) * 0.05)(B, S, D)),
            "w_gate": _w((lambda *s: torch.randn(*s, dtype=torch.bfloat16) * 0.05)(D, F)),
            "w_up": _w((lambda *s: torch.randn(*s, dtype=torch.bfloat16) * 0.05)(D, F)),
            "w_down": _w((lambda *s: torch.randn(*s, dtype=torch.bfloat16) * 0.05)(F, D)),
        }
    _B_in = _B_setup()

    return {
        "A_x": _A_in["x"],
        "A_k_cache": _A_in["k_cache"],
        "A_v_cache": _A_in["v_cache"],
        "A_wq": _A_in["wq"],
        "A_wo": _A_in["wo"],
        "B_x": _B_in["x"],
        "B_w_gate": _B_in["w_gate"],
        "B_w_up": _B_in["w_up"],
        "B_w_down": _B_in["w_down"],
    }

def reference(A_x, A_k_cache, A_v_cache, A_wq, A_wo, B_x, B_w_gate, B_w_up, B_w_down):
    def _A_ref(x, k_cache, v_cache, wq, wo):
        B, Sq, D = x.shape
        Hq, Dh = 32, 128
        Hkv = k_cache.shape[1]
        rep = Hq // Hkv
        q = (lambda x, *d: x.permute(*d))((x @ wq).reshape(B, Sq, Hq, Dh), 0, 2, 1, 3)
        k = (lambda x, n, axis: torch.repeat_interleave(x, n, dim=axis))(k_cache, rep, axis=1)
        v = (lambda x, n, axis: torch.repeat_interleave(x, n, dim=axis))(v_cache, rep, axis=1)
        scores = torch.einsum("bhqd,bhkd->bhqk", q, k) * (Dh ** -0.5)
        p = _softmax(scores, axis=-1)
        o = torch.einsum("bhqk,bhkd->bhqd", p, v)
        return (lambda x, *d: x.permute(*d))(o, 0, 2, 1, 3).reshape(B, Sq, Hq * Dh) @ wo

    def _B_ref(x, w_gate, w_up, w_down):
        return (_gelu(x @ w_gate) * (x @ w_up)) @ w_down

    x = A_x
    h = x + _A_ref(_layernorm(x, axis=-1), A_k_cache, A_v_cache, A_wq, A_wo)
    h2 = h + _B_ref(_layernorm(h, axis=-1), B_w_gate, B_w_up, B_w_down)
    return h2
```

```asm
; @launch grid=(256,1,1) block=(512,1,1) lds=147456
.amdgcn_target "amdgcn-amd-amdhsa--gfx950"
.text
.globl sequential_preLN__gqa_block_cached__geglu_ffn__decode_kernel
.p2align 8
.type sequential_preLN__gqa_block_cached__geglu_ffn__decode_kernel,@function
sequential_preLN__gqa_block_cached__geglu_ffn__decode_kernel:
    s_cmp_ge_u32 s2, 256
    s_cbranch_scc1 L_exit
    s_load_dwordx16 s[16:31], s[0:1], 0
    s_load_dwordx8 s[32:39], s[0:1], 64
    v_lshrrev_b32 v2, 6, v0
    v_and_b32 v1, 63, v0
    v_readfirstlane_b32 s3, v2
    s_sub_u32 s15, s2, 64
    s_and_b32 s4, s15, 7
    s_lshr_b32 s5, s15, 3
    s_and_b32 s5, s5, 31
    s_mul_i32 s66, s5, 43
    s_lshr_b32 s66, s66, 7
    s_mul_i32 s8, s66, 3
    s_sub_u32 s8, s5, s8
    s_lshr_b32 s6, s66, 1
    s_lshl_b32 s6, s6, 3
    s_add_u32 s6, s6, s4
    s_and_b32 s66, s66, 1
    s_lshl_b32 s66, s66, 5
    s_add_u32 s6, s6, s66
    s_and_b32 s6, s6, 63
    s_lshl_b32 s66, s6, 21
    s_mul_i32 s67, s8, 699392
    s_add_u32 s66, s66, s67
    s_cmp_eq_u32 s8, 2
    s_cselect_b32 s13, 1, 0
    s_sub_u32 s13, 683, s13
    s_lshl_b32 s67, s13, 10
    v_lshlrev_b32 v8, 4, v0
    s_mov_b32 s64, 0
    s_movk_i32 s11, 8192
    s_mov_b64 s[78:79], -1
    s_mov_b32 s83, 0
    v_lshrrev_b32 v2, 4, v1
    v_and_b32 v3, 15, v1
    s_waitcnt lgkmcnt(0)
    s_add_u32 s44, s18, s66
    s_addc_u32 s45, s19, 0
    s_mov_b32 s46, s67
    s_mov_b32 s47, 0x20000
    s_load_dword s12, s[38:39], 360448
    s_mov_b32 s40, s38
    s_mov_b32 s41, s39
    s_mov_b32 s42, 2097152
    s_mov_b32 s43, 0x20000
    s_cmp_lt_u32 s2, 64
    s_cbranch_scc1 L_service
    buffer_load_dwordx4 v[64:67], v8, s[44:47], s64 offen nt
    s_add_u32 s64, s64, s11
    buffer_load_dwordx4 v[68:71], v8, s[44:47], s64 offen nt
    s_add_u32 s64, s64, s11
    buffer_load_dwordx4 v[72:75], v8, s[44:47], s64 offen nt
    s_add_u32 s64, s64, s11
    buffer_load_dwordx4 v[76:79], v8, s[44:47], s64 offen nt
    s_add_u32 s64, s64, s11
    v_lshlrev_b32 v28, 2, v1
    v_cmp_gt_u32 vcc, 16, v1
    s_nop 1
    v_cndmask_b32 v30, 0, -1, vcc
    s_mov_b64 exec, 0x3ffff
    ds_write_b32 v28, v30 offset:256
    s_mov_b64 exec, -1
    s_mov_b32 s56, s16
    s_mov_b32 s57, s17
    s_mov_b32 s58, 2560
    s_mov_b32 s59, 0x20000
    s_mov_b32 s92, s34
    s_mov_b32 s93, s35
    s_mov_b32 s94, 2560
    s_mov_b32 s95, 0x20000
    s_add_u32 s70, s20, s66
    s_addc_u32 s71, s21, 0
    s_mul_i32 s9, s6, 3
    s_add_u32 s9, s9, s8
    s_waitcnt lgkmcnt(0)
    s_barrier
    s_mul_i32 s12, s12, 0x9E3779B1
    s_add_u32 s12, s12, 0x7F4A7C15
    s_and_b32 s60, s12, 0xff
    v_mov_b32 v63, 0xff
    v_and_b32 v9, 1, v3
    v_lshlrev_b32 v9, 4, v9
    v_mov_b32 v7, 0xffff
    v_lshlrev_b32 v9, v9, v7
    v_lshrrev_b32 v7, 1, v3
    v_cmp_eq_u32 vcc, 0, v7
    s_nop 1
    v_cndmask_b32 v4, 0, v9, vcc
    v_cmp_eq_u32 vcc, 1, v7
    s_nop 1
    v_cndmask_b32 v5, 0, v9, vcc
    v_cmp_eq_u32 vcc, 2, v7
    s_nop 1
    v_cndmask_b32 v6, 0, v9, vcc
    v_cmp_eq_u32 vcc, 3, v7
    s_nop 1
    v_cndmask_b32 v7, 0, v9, vcc
    v_lshlrev_b32 v32, 3, v1
    v_mov_b32 v29, 0
    s_and_b32 s68, s6, 31
    s_lshl_b32 s68, s68, 11
    s_lshr_b32 s69, s6, 5
    s_lshl_b32 s69, s69, 9
    s_add_u32 s68, s68, s69
    s_add_u32 s68, s68, 294912
    v_lshlrev_b32 v30, 4, v1
    v_bfe_u32 v31, v1, 1, 4
    v_lshlrev_b32 v31, 4, v31
    v_lshrrev_b32 v28, 5, v1
    v_lshl_add_u32 v31, v28, 3, v31
    v_and_b32 v28, 1, v1
    v_lshl_add_u32 v31, v28, 2, v31
    v_lshlrev_b32 v28, 4, v3
    s_waitcnt vmcnt(3)
    buffer_load_dwordx4 v[80:83], v8, s[44:47], s64 offen nt
    s_add_u32 s64, s64, s11
    s_waitcnt vmcnt(3)
    buffer_load_dwordx4 v[84:87], v8, s[44:47], s64 offen nt
    s_add_u32 s64, s64, s11
    s_waitcnt vmcnt(3)
    buffer_load_dwordx4 v[88:91], v8, s[44:47], s64 offen nt
    s_add_u32 s64, s64, s11
    s_waitcnt vmcnt(3)
    buffer_load_dwordx4 v[92:95], v8, s[44:47], s64 offen nt
    s_add_u32 s64, s64, s11
    s_waitcnt vmcnt(3)
    buffer_load_dwordx4 v[96:99], v8, s[44:47], s64 offen nt
    s_add_u32 s64, s64, s11
    s_waitcnt vmcnt(3)
    buffer_load_dwordx4 v[100:103], v8, s[44:47], s64 offen nt
    s_add_u32 s64, s64, s11
    s_waitcnt vmcnt(3)
    buffer_load_dwordx4 v[104:107], v8, s[44:47], s64 offen nt
    s_add_u32 s64, s64, s11
    s_waitcnt vmcnt(3)
    buffer_load_dwordx4 v[108:111], v8, s[44:47], s64 offen nt
    s_add_u32 s64, s64, s11
    s_waitcnt vmcnt(3)
    buffer_load_dwordx4 v[112:115], v8, s[44:47], s64 offen nt
    s_add_u32 s64, s64, s11
    s_waitcnt vmcnt(3)
    buffer_load_dwordx4 v[116:119], v8, s[44:47], s64 offen nt
    s_add_u32 s64, s64, s11
    s_waitcnt vmcnt(3)
    buffer_load_dwordx4 v[120:123], v8, s[44:47], s64 offen nt
    s_add_u32 s64, s64, s11
    s_waitcnt vmcnt(3)
    buffer_load_dwordx4 v[124:127], v8, s[44:47], s64 offen nt
    s_add_u32 s64, s64, s11
    s_waitcnt vmcnt(3)
    buffer_load_dwordx4 v[128:131], v8, s[44:47], s64 offen nt
    s_add_u32 s64, s64, s11
    s_waitcnt vmcnt(3)
    buffer_load_dwordx4 v[132:135], v8, s[44:47], s64 offen nt
    s_add_u32 s64, s64, s11
    s_waitcnt vmcnt(3)
    buffer_load_dwordx4 v[136:139], v8, s[44:47], s64 offen nt
    s_add_u32 s64, s64, s11
    s_waitcnt vmcnt(3)
    buffer_load_dwordx4 v[140:143], v8, s[44:47], s64 offen nt
    s_add_u32 s64, s64, s11
    s_waitcnt vmcnt(3)
    buffer_load_dwordx4 v[144:147], v8, s[44:47], s64 offen nt
    s_add_u32 s64, s64, s11
    s_waitcnt vmcnt(3)
    buffer_load_dwordx4 v[148:151], v8, s[44:47], s64 offen nt
    s_add_u32 s64, s64, s11
    s_waitcnt vmcnt(3)
    buffer_load_dwordx4 v[152:155], v8, s[44:47], s64 offen nt
    s_add_u32 s64, s64, s11
    s_waitcnt vmcnt(3)
    buffer_load_dwordx4 v[156:159], v8, s[44:47], s64 offen nt
    s_add_u32 s64, s64, s11
    s_waitcnt vmcnt(3)
    buffer_load_dwordx4 v[160:163], v8, s[44:47], s64 offen nt
    s_add_u32 s64, s64, s11
    s_waitcnt vmcnt(3)
    buffer_load_dwordx4 v[164:167], v8, s[44:47], s64 offen nt
    s_add_u32 s64, s64, s11
    s_waitcnt vmcnt(3)
    buffer_load_dwordx4 v[168:171], v8, s[44:47], s64 offen nt
    s_add_u32 s64, s64, s11
    s_waitcnt vmcnt(3)
    buffer_load_dwordx4 v[172:175], v8, s[44:47], s64 offen nt
    s_add_u32 s64, s64, s11
    s_waitcnt vmcnt(3)
    buffer_load_dwordx4 v[176:179], v8, s[44:47], s64 offen nt
    s_add_u32 s64, s64, s11
    s_waitcnt vmcnt(3)
    buffer_load_dwordx4 v[180:183], v8, s[44:47], s64 offen nt
    s_add_u32 s64, s64, s11
    s_waitcnt vmcnt(3)
    buffer_load_dwordx4 v[184:187], v8, s[44:47], s64 offen nt
    s_add_u32 s64, s64, s11
    s_waitcnt vmcnt(3)
    buffer_load_dwordx4 v[188:191], v8, s[44:47], s64 offen nt
    s_add_u32 s64, s64, s11
    s_waitcnt vmcnt(3)
    buffer_load_dwordx4 v[192:195], v8, s[44:47], s64 offen nt
    s_add_u32 s64, s64, s11
    s_cmp_lg_u32 s3, 0
    s_cbranch_scc1 L_p2
    buffer_load_dwordx2 v[44:45], v32, s[40:43], s68 offen sc1
    buffer_load_dwordx2 v[46:47], v32, s[40:43], s68 offen offset:1024 sc1
L_p2:
    s_waitcnt vmcnt(3)
    buffer_load_dwordx4 v[196:199], v8, s[44:47], s64 offen nt
    s_add_u32 s64, s64, s11
    s_waitcnt vmcnt(3)
    buffer_load_dwordx4 v[200:203], v8, s[44:47], s64 offen nt
    s_add_u32 s64, s64, s11
    s_waitcnt vmcnt(3)
    buffer_load_dwordx4 v[204:207], v8, s[44:47], s64 offen nt
    s_add_u32 s64, s64, s11
    s_waitcnt vmcnt(3)
    buffer_load_dwordx4 v[208:211], v8, s[44:47], s64 offen nt
    s_add_u32 s64, s64, s11
    s_waitcnt vmcnt(3)
    buffer_load_dwordx4 v[212:215], v8, s[44:47], s64 offen nt
    s_add_u32 s64, s64, s11
    s_cmp_lg_u32 s3, 0
    s_cbranch_scc1 L_p3
    s_and_b32 s69, s12, 15
    v_xor_b32 v44, s69, v44
    v_xor_b32 v45, s69, v45
    v_xor_b32 v46, s69, v46
    v_xor_b32 v47, s69, v47
    v_or3_b32 v48, v44, v45, v46
    v_or_b32 v48, v48, v47
    v_and_b32 v48, 15, v48
    v_cmp_ne_u32 vcc, 0, v48
    s_cbranch_vccz L_qok
    s_mov_b32 s82, 400000
L_qpoll:
    buffer_load_dwordx2 v[44:45], v32, s[40:43], s68 offen sc1
    buffer_load_dwordx2 v[46:47], v32, s[40:43], s68 offen offset:1024 sc1
    s_sub_u32 s82, s82, 1
    s_cmp_eq_u32 s82, 0
    s_cselect_b64 s[76:77], 0, -1
    s_waitcnt vmcnt(0)
    s_and_b32 s69, s12, 15
    v_xor_b32 v44, s69, v44
    v_xor_b32 v45, s69, v45
    v_xor_b32 v46, s69, v46
    v_xor_b32 v47, s69, v47
    v_or3_b32 v48, v44, v45, v46
    v_or_b32 v48, v48, v47
    v_and_b32 v48, 15, v48
    v_cmp_ne_u32 vcc, 0, v48
    s_nop 0
    s_and_b64 vcc, vcc, s[76:77]
    s_cbranch_vccnz L_qpoll
L_qok:
    v_pk_add_f32 v[44:45], v[44:45], v[46:47]
    v_cvt_pk_bf16_f32 v44, v44, v45
    v_mov_b32 v45, 1
    ds_write_b32 v31, v44 offset:0
    ds_write_b32 v29, v45 offset:324
L_p3:
    s_waitcnt vmcnt(3)
    buffer_load_dwordx4 v[216:219], v8, s[44:47], s64 offen nt
    s_add_u32 s64, s64, s11
    s_waitcnt vmcnt(3)
    buffer_load_dwordx4 v[220:223], v8, s[44:47], s64 offen nt
    s_add_u32 s64, s64, s11
    s_waitcnt vmcnt(3)
    buffer_load_dwordx4 v[224:227], v8, s[44:47], s64 offen nt
    s_add_u32 s64, s64, s11
    s_waitcnt vmcnt(3)
    buffer_load_dwordx4 v[228:231], v8, s[44:47], s64 offen nt
    s_add_u32 s64, s64, s11
    s_waitcnt vmcnt(3)
    buffer_load_dwordx4 v[232:235], v8, s[44:47], s64 offen nt
    s_add_u32 s64, s64, s11
    s_waitcnt vmcnt(3)
    buffer_load_dwordx4 v[236:239], v8, s[44:47], s64 offen nt
    s_add_u32 s64, s64, s11
    s_mov_b32 s82, 400000
L_qget:
    ds_read_b32 v44, v29 offset:324
    ds_read_b128 v[10:13], v28 offset:0
    s_sub_u32 s82, s82, 1
    s_cmp_eq_u32 s82, 0
    s_cselect_b64 s[76:77], 0, -1
    s_waitcnt lgkmcnt(0)
    v_cmp_eq_u32 vcc, 0, v44
    s_nop 0
    s_and_b64 vcc, vcc, s[76:77]
    s_cbranch_vccnz L_qget
    v_and_b32 v28, 3, v3
    v_cmp_eq_u32 s[72:73], 1, v28
    v_cmp_eq_u32 s[74:75], 2, v28
    v_cmp_eq_u32 s[76:77], 3, v28
    s_mov_b32 s69, 0x3db504f3
    v_dot2_f32_bf16 v44, v64, v10, 0
    v_dot2_f32_bf16 v44, v65, v11, v44
    v_dot2_f32_bf16 v44, v66, v12, v44
    v_dot2_f32_bf16 v44, v67, v13, v44
    v_dot2_f32_bf16 v45, v68, v10, 0
    v_dot2_f32_bf16 v45, v69, v11, v45
    v_dot2_f32_bf16 v45, v70, v12, v45
    v_dot2_f32_bf16 v45, v71, v13, v45
    s_waitcnt vmcnt(3)
    buffer_load_dwordx4 v[240:243], v8, s[44:47], s64 offen nt
    s_add_u32 s64, s64, s11
    v_dot2_f32_bf16 v46, v72, v10, 0
    v_dot2_f32_bf16 v46, v73, v11, v46
    v_dot2_f32_bf16 v46, v74, v12, v46
    v_dot2_f32_bf16 v46, v75, v13, v46
    v_dot2_f32_bf16 v47, v76, v10, 0
    v_dot2_f32_bf16 v47, v77, v11, v47
    v_dot2_f32_bf16 v47, v78, v12, v47
    v_dot2_f32_bf16 v47, v79, v13, v47
    v_dot2_f32_bf16 v48, v80, v10, 0
    v_dot2_f32_bf16 v48, v81, v11, v48
    v_dot2_f32_bf16 v48, v82, v12, v48
    v_dot2_f32_bf16 v48, v83, v13, v48
    v_dot2_f32_bf16 v49, v84, v10, 0
    v_dot2_f32_bf16 v49, v85, v11, v49
    v_dot2_f32_bf16 v49, v86, v12, v49
    v_dot2_f32_bf16 v49, v87, v13, v49
    s_waitcnt vmcnt(3)
    buffer_load_dwordx4 v[244:247], v8, s[44:47], s64 offen nt
    s_add_u32 s64, s64, s11
    v_dot2_f32_bf16 v50, v88, v10, 0
    v_dot2_f32_bf16 v50, v89, v11, v50
    v_dot2_f32_bf16 v50, v90, v12, v50
    v_dot2_f32_bf16 v50, v91, v13, v50
    v_dot2_f32_bf16 v51, v92, v10, 0
    v_dot2_f32_bf16 v51, v93, v11, v51
    v_dot2_f32_bf16 v51, v94, v12, v51
    v_dot2_f32_bf16 v51, v95, v13, v51
    v_dot2_f32_bf16 v52, v96, v10, 0
    v_dot2_f32_bf16 v52, v97, v11, v52
    v_dot2_f32_bf16 v52, v98, v12, v52
    v_dot2_f32_bf16 v52, v99, v13, v52
    v_dot2_f32_bf16 v53, v100, v10, 0
    v_dot2_f32_bf16 v53, v101, v11, v53
    v_dot2_f32_bf16 v53, v102, v12, v53
    v_dot2_f32_bf16 v53, v103, v13, v53
    s_waitcnt vmcnt(3)
    buffer_load_dwordx4 v[248:251], v8, s[44:47], s64 offen nt
    s_add_u32 s64, s64, s11
    v_dot2_f32_bf16 v54, v104, v10, 0
    v_dot2_f32_bf16 v54, v105, v11, v54
    v_dot2_f32_bf16 v54, v106, v12, v54
    v_dot2_f32_bf16 v54, v107, v13, v54
    v_dot2_f32_bf16 v55, v108, v10, 0
    v_dot2_f32_bf16 v55, v109, v11, v55
    v_dot2_f32_bf16 v55, v110, v12, v55
    v_dot2_f32_bf16 v55, v111, v13, v55
    v_dot2_f32_bf16 v56, v112, v10, 0
    v_dot2_f32_bf16 v56, v113, v11, v56
    v_dot2_f32_bf16 v56, v114, v12, v56
    v_dot2_f32_bf16 v56, v115, v13, v56
    v_dot2_f32_bf16 v57, v116, v10, 0
    v_dot2_f32_bf16 v57, v117, v11, v57
    v_dot2_f32_bf16 v57, v118, v12, v57
    v_dot2_f32_bf16 v57, v119, v13, v57
    s_waitcnt vmcnt(3)
    buffer_load_dwordx4 v[252:255], v8, s[44:47], s64 offen nt
    s_add_u32 s64, s64, s11
    v_dot2_f32_bf16 v58, v120, v10, 0
    v_dot2_f32_bf16 v58, v121, v11, v58
    v_dot2_f32_bf16 v58, v122, v12, v58
    v_dot2_f32_bf16 v58, v123, v13, v58
    v_dot2_f32_bf16 v59, v124, v10, 0
    v_dot2_f32_bf16 v59, v125, v11, v59
    v_dot2_f32_bf16 v59, v126, v12, v59
    v_dot2_f32_bf16 v59, v127, v13, v59
    v_add_f32_dpp v44, v44, v44 row_ror:8 row_mask:0xf bank_mask:0x3
    v_add_f32_dpp v45, v45, v45 row_ror:8 row_mask:0xf bank_mask:0x3
    v_add_f32_dpp v46, v46, v46 row_ror:8 row_mask:0xf bank_mask:0x3
    v_add_f32_dpp v47, v47, v47 row_ror:8 row_mask:0xf bank_mask:0x3
    v_add_f32_dpp v48, v48, v48 row_ror:8 row_mask:0xf bank_mask:0x3
    v_add_f32_dpp v49, v49, v49 row_ror:8 row_mask:0xf bank_mask:0x3
    v_add_f32_dpp v50, v50, v50 row_ror:8 row_mask:0xf bank_mask:0x3
    v_add_f32_dpp v51, v51, v51 row_ror:8 row_mask:0xf bank_mask:0x3
    v_add_f32_dpp v44, v52, v52 row_ror:8 row_mask:0xf bank_mask:0xc
    v_add_f32_dpp v45, v53, v53 row_ror:8 row_mask:0xf bank_mask:0xc
    v_add_f32_dpp v46, v54, v54 row_ror:8 row_mask:0xf bank_mask:0xc
    v_add_f32_dpp v47, v55, v55 row_ror:8 row_mask:0xf bank_mask:0xc
    s_waitcnt vmcnt(3)
    buffer_load_dwordx4 v[64:67], v8, s[44:47], s64 offen nt
    s_add_u32 s64, s64, s11
    v_add_f32_dpp v48, v56, v56 row_ror:8 row_mask:0xf bank_mask:0xc
    v_add_f32_dpp v49, v57, v57 row_ror:8 row_mask:0xf bank_mask:0xc
    v_add_f32_dpp v50, v58, v58 row_ror:8 row_mask:0xf bank_mask:0xc
    v_add_f32_dpp v51, v59, v59 row_ror:8 row_mask:0xf bank_mask:0xc
    v_add_f32_dpp v44, v44, v44 row_shl:4 row_mask:0xf bank_mask:0x5
    v_add_f32_dpp v45, v45, v45 row_shl:4 row_mask:0xf bank_mask:0x5
    v_add_f32_dpp v46, v46, v46 row_shl:4 row_mask:0xf bank_mask:0x5
    v_add_f32_dpp v47, v47, v47 row_shl:4 row_mask:0xf bank_mask:0x5
    v_add_f32_dpp v44, v48, v48 row_shr:4 row_mask:0xf bank_mask:0xa
    v_add_f32_dpp v45, v49, v49 row_shr:4 row_mask:0xf bank_mask:0xa
    v_add_f32_dpp v46, v50, v50 row_shr:4 row_mask:0xf bank_mask:0xa
    v_add_f32_dpp v47, v51, v51 row_shr:4 row_mask:0xf bank_mask:0xa
    v_add_f32_dpp v44, v44, v44 quad_perm:[2,3,0,1] row_mask:0xf bank_mask:0xf
    v_add_f32_dpp v45, v45, v45 quad_perm:[2,3,0,1] row_mask:0xf bank_mask:0xf
    v_add_f32_dpp v46, v46, v46 quad_perm:[2,3,0,1] row_mask:0xf bank_mask:0xf
    v_add_f32_dpp v47, v47, v47 quad_perm:[2,3,0,1] row_mask:0xf bank_mask:0xf
    v_add_f32_dpp v44, v44, v44 quad_perm:[1,0,3,2] row_mask:0xf bank_mask:0xf
    v_add_f32_dpp v45, v45, v45 quad_perm:[1,0,3,2] row_mask:0xf bank_mask:0xf
    v_add_f32_dpp v46, v46, v46 quad_perm:[1,0,3,2] row_mask:0xf bank_mask:0xf
    v_add_f32_dpp v47, v47, v47 quad_perm:[1,0,3,2] row_mask:0xf bank_mask:0xf
    v_cndmask_b32 v44, v44, v45, s[72:73]
    v_cndmask_b32 v44, v44, v46, s[74:75]
    v_cndmask_b32 v44, v44, v47, s[76:77]
    v_cvt_pk_bf16_f32 v44, v44, v44
    s_waitcnt vmcnt(3)
    buffer_load_dwordx4 v[68:71], v8, s[44:47], s64 offen nt
    s_add_u32 s64, s64, s11
    v_and_b32 v44, 0xffff0000, v44
    v_mul_f32 v44, s69, v44
    v_cvt_pk_bf16_f32 v36, v44, v44
    v_and_b32 v36, 0xffff0000, v36
    v_dot2_f32_bf16 v44, v128, v10, 0
    v_dot2_f32_bf16 v44, v129, v11, v44
    v_dot2_f32_bf16 v44, v130, v12, v44
    v_dot2_f32_bf16 v44, v131, v13, v44
    v_dot2_f32_bf16 v45, v132, v10, 0
    v_dot2_f32_bf16 v45, v133, v11, v45
    v_dot2_f32_bf16 v45, v134, v12, v45
    v_dot2_f32_bf16 v45, v135, v13, v45
    v_dot2_f32_bf16 v46, v136, v10, 0
    v_dot2_f32_bf16 v46, v137, v11, v46
    v_dot2_f32_bf16 v46, v138, v12, v46
    v_dot2_f32_bf16 v46, v139, v13, v46
    v_dot2_f32_bf16 v47, v140, v10, 0
    v_dot2_f32_bf16 v47, v141, v11, v47
    v_dot2_f32_bf16 v47, v142, v12, v47
    v_dot2_f32_bf16 v47, v143, v13, v47
    s_waitcnt vmcnt(3)
    buffer_load_dwordx4 v[72:75], v8, s[44:47], s64 offen nt
    s_add_u32 s64, s64, s11
    v_dot2_f32_bf16 v48, v144, v10, 0
    v_dot2_f32_bf16 v48, v145, v11, v48
    v_dot2_f32_bf16 v48, v146, v12, v48
    v_dot2_f32_bf16 v48, v147, v13, v48
    v_dot2_f32_bf16 v49, v148, v10, 0
    v_dot2_f32_bf16 v49, v149, v11, v49
    v_dot2_f32_bf16 v49, v150, v12, v49
    v_dot2_f32_bf16 v49, v151, v13, v49
    v_dot2_f32_bf16 v50, v152, v10, 0
    v_dot2_f32_bf16 v50, v153, v11, v50
    v_dot2_f32_bf16 v50, v154, v12, v50
    v_dot2_f32_bf16 v50, v155, v13, v50
    v_dot2_f32_bf16 v51, v156, v10, 0
    v_dot2_f32_bf16 v51, v157, v11, v51
    v_dot2_f32_bf16 v51, v158, v12, v51
    v_dot2_f32_bf16 v51, v159, v13, v51
    s_waitcnt vmcnt(3)
    buffer_load_dwordx4 v[76:79], v8, s[44:47], s64 offen nt
    s_add_u32 s64, s64, s11
    v_dot2_f32_bf16 v52, v160, v10, 0
    v_dot2_f32_bf16 v52, v161, v11, v52
    v_dot2_f32_bf16 v52, v162, v12, v52
    v_dot2_f32_bf16 v52, v163, v13, v52
    v_dot2_f32_bf16 v53, v164, v10, 0
    v_dot2_f32_bf16 v53, v165, v11, v53
    v_dot2_f32_bf16 v53, v166, v12, v53
    v_dot2_f32_bf16 v53, v167, v13, v53
    v_dot2_f32_bf16 v54, v168, v10, 0
    v_dot2_f32_bf16 v54, v169, v11, v54
    v_dot2_f32_bf16 v54, v170, v12, v54
    v_dot2_f32_bf16 v54, v171, v13, v54
    v_dot2_f32_bf16 v55, v172, v10, 0
    v_dot2_f32_bf16 v55, v173, v11, v55
    v_dot2_f32_bf16 v55, v174, v12, v55
    v_dot2_f32_bf16 v55, v175, v13, v55
    s_waitcnt vmcnt(3)
    buffer_load_dwordx4 v[80:83], v8, s[44:47], s64 offen nt
    s_add_u32 s64, s64, s11
    v_dot2_f32_bf16 v56, v176, v10, 0
    v_dot2_f32_bf16 v56, v177, v11, v56
    v_dot2_f32_bf16 v56, v178, v12, v56
    v_dot2_f32_bf16 v56, v179, v13, v56
    v_dot2_f32_bf16 v57, v180, v10, 0
    v_dot2_f32_bf16 v57, v181, v11, v57
    v_dot2_f32_bf16 v57, v182, v12, v57
    v_dot2_f32_bf16 v57, v183, v13, v57
    v_dot2_f32_bf16 v58, v184, v10, 0
    v_dot2_f32_bf16 v58, v185, v11, v58
    v_dot2_f32_bf16 v58, v186, v12, v58
    v_dot2_f32_bf16 v58, v187, v13, v58
    v_dot2_f32_bf16 v59, v188, v10, 0
    v_dot2_f32_bf16 v59, v189, v11, v59
    v_dot2_f32_bf16 v59, v190, v12, v59
    v_dot2_f32_bf16 v59, v191, v13, v59
    s_waitcnt vmcnt(3)
    buffer_load_dwordx4 v[84:87], v8, s[44:47], s64 offen nt
    s_add_u32 s64, s64, s11
    v_add_f32_dpp v44, v44, v44 row_ror:8 row_mask:0xf bank_mask:0x3
    v_add_f32_dpp v45, v45, v45 row_ror:8 row_mask:0xf bank_mask:0x3
    v_add_f32_dpp v46, v46, v46 row_ror:8 row_mask:0xf bank_mask:0x3
    v_add_f32_dpp v47, v47, v47 row_ror:8 row_mask:0xf bank_mask:0x3
    v_add_f32_dpp v48, v48, v48 row_ror:8 row_mask:0xf bank_mask:0x3
    v_add_f32_dpp v49, v49, v49 row_ror:8 row_mask:0xf bank_mask:0x3
    v_add_f32_dpp v50, v50, v50 row_ror:8 row_mask:0xf bank_mask:0x3
    v_add_f32_dpp v51, v51, v51 row_ror:8 row_mask:0xf bank_mask:0x3
    v_add_f32_dpp v44, v52, v52 row_ror:8 row_mask:0xf bank_mask:0xc
    v_add_f32_dpp v45, v53, v53 row_ror:8 row_mask:0xf bank_mask:0xc
    v_add_f32_dpp v46, v54, v54 row_ror:8 row_mask:0xf bank_mask:0xc
    v_add_f32_dpp v47, v55, v55 row_ror:8 row_mask:0xf bank_mask:0xc
    v_add_f32_dpp v48, v56, v56 row_ror:8 row_mask:0xf bank_mask:0xc
    v_add_f32_dpp v49, v57, v57 row_ror:8 row_mask:0xf bank_mask:0xc
    v_add_f32_dpp v50, v58, v58 row_ror:8 row_mask:0xf bank_mask:0xc
    v_add_f32_dpp v51, v59, v59 row_ror:8 row_mask:0xf bank_mask:0xc
    v_add_f32_dpp v44, v44, v44 row_shl:4 row_mask:0xf bank_mask:0x5
    v_add_f32_dpp v45, v45, v45 row_shl:4 row_mask:0xf bank_mask:0x5
    v_add_f32_dpp v46, v46, v46 row_shl:4 row_mask:0xf bank_mask:0x5
    v_add_f32_dpp v47, v47, v47 row_shl:4 row_mask:0xf bank_mask:0x5
    v_add_f32_dpp v44, v48, v48 row_shr:4 row_mask:0xf bank_mask:0xa
    v_add_f32_dpp v45, v49, v49 row_shr:4 row_mask:0xf bank_mask:0xa
    v_add_f32_dpp v46, v50, v50 row_shr:4 row_mask:0xf bank_mask:0xa
    v_add_f32_dpp v47, v51, v51 row_shr:4 row_mask:0xf bank_mask:0xa
    s_waitcnt vmcnt(3)
    buffer_load_dwordx4 v[88:91], v8, s[44:47], s64 offen nt
    s_add_u32 s64, s64, s11
    v_add_f32_dpp v44, v44, v44 quad_perm:[2,3,0,1] row_mask:0xf bank_mask:0xf
    v_add_f32_dpp v45, v45, v45 quad_perm:[2,3,0,1] row_mask:0xf bank_mask:0xf
    v_add_f32_dpp v46, v46, v46 quad_perm:[2,3,0,1] row_mask:0xf bank_mask:0xf
    v_add_f32_dpp v47, v47, v47 quad_perm:[2,3,0,1] row_mask:0xf bank_mask:0xf
    v_add_f32_dpp v44, v44, v44 quad_perm:[1,0,3,2] row_mask:0xf bank_mask:0xf
    v_add_f32_dpp v45, v45, v45 quad_perm:[1,0,3,2] row_mask:0xf bank_mask:0xf
    v_add_f32_dpp v46, v46, v46 quad_perm:[1,0,3,2] row_mask:0xf bank_mask:0xf
    v_add_f32_dpp v47, v47, v47 quad_perm:[1,0,3,2] row_mask:0xf bank_mask:0xf
    v_cndmask_b32 v44, v44, v45, s[72:73]
    v_cndmask_b32 v44, v44, v46, s[74:75]
    v_cndmask_b32 v44, v44, v47, s[76:77]
    v_cvt_pk_bf16_f32 v44, v44, v44
    v_and_b32 v44, 0xffff0000, v44
    v_mul_f32 v44, s69, v44
    v_cvt_pk_bf16_f32 v37, v44, v44
    v_and_b32 v37, 0xffff0000, v37
    v_dot2_f32_bf16 v44, v192, v10, 0
    v_dot2_f32_bf16 v44, v193, v11, v44
    v_dot2_f32_bf16 v44, v194, v12, v44
    v_dot2_f32_bf16 v44, v195, v13, v44
    v_dot2_f32_bf16 v45, v196, v10, 0
    v_dot2_f32_bf16 v45, v197, v11, v45
    v_dot2_f32_bf16 v45, v198, v12, v45
    v_dot2_f32_bf16 v45, v199, v13, v45
    s_waitcnt vmcnt(3)
    buffer_load_dwordx4 v[92:95], v8, s[44:47], s64 offen nt
    s_add_u32 s64, s64, s11
    v_dot2_f32_bf16 v46, v200, v10, 0
    v_dot2_f32_bf16 v46, v201, v11, v46
    v_dot2_f32_bf16 v46, v202, v12, v46
    v_dot2_f32_bf16 v46, v203, v13, v46
    v_dot2_f32_bf16 v47, v204, v10, 0
    v_dot2_f32_bf16 v47, v205, v11, v47
    v_dot2_f32_bf16 v47, v206, v12, v47
    v_dot2_f32_bf16 v47, v207, v13, v47
    v_dot2_f32_bf16 v48, v208, v10, 0
    v_dot2_f32_bf16 v48, v209, v11, v48
    v_dot2_f32_bf16 v48, v210, v12, v48
    v_dot2_f32_bf16 v48, v211, v13, v48
    v_dot2_f32_bf16 v49, v212, v10, 0
    v_dot2_f32_bf16 v49, v213, v11, v49
    v_dot2_f32_bf16 v49, v214, v12, v49
    v_dot2_f32_bf16 v49, v215, v13, v49
    s_waitcnt vmcnt(3)
    buffer_load_dwordx4 v[96:99], v8, s[44:47], s64 offen nt
    s_add_u32 s64, s64, s11
    v_dot2_f32_bf16 v50, v216, v10, 0
    v_dot2_f32_bf16 v50, v217, v11, v50
    v_dot2_f32_bf16 v50, v218, v12, v50
    v_dot2_f32_bf16 v50, v219, v13, v50
    v_dot2_f32_bf16 v51, v220, v10, 0
    v_dot2_f32_bf16 v51, v221, v11, v51
    v_dot2_f32_bf16 v51, v222, v12, v51
    v_dot2_f32_bf16 v51, v223, v13, v51
    v_dot2_f32_bf16 v52, v224, v10, 0
    v_dot2_f32_bf16 v52, v225, v11, v52
    v_dot2_f32_bf16 v52, v226, v12, v52
    v_dot2_f32_bf16 v52, v227, v13, v52
    v_dot2_f32_bf16 v53, v228, v10, 0
    v_dot2_f32_bf16 v53, v229, v11, v53
    v_dot2_f32_bf16 v53, v230, v12, v53
    v_dot2_f32_bf16 v53, v231, v13, v53
    s_waitcnt vmcnt(3)
    buffer_load_dwordx4 v[100:103], v8, s[44:47], s64 offen nt
    s_add_u32 s64, s64, s11
    v_dot2_f32_bf16 v54, v232, v10, 0
    v_dot2_f32_bf16 v54, v233, v11, v54
    v_dot2_f32_bf16 v54, v234, v12, v54
    v_dot2_f32_bf16 v54, v235, v13, v54
    v_dot2_f32_bf16 v55, v236, v10, 0
    v_dot2_f32_bf16 v55, v237, v11, v55
    v_dot2_f32_bf16 v55, v238, v12, v55
    v_dot2_f32_bf16 v55, v239, v13, v55
    v_dot2_f32_bf16 v56, v240, v10, 0
    v_dot2_f32_bf16 v56, v241, v11, v56
    v_dot2_f32_bf16 v56, v242, v12, v56
    v_dot2_f32_bf16 v56, v243, v13, v56
    v_dot2_f32_bf16 v57, v244, v10, 0
    v_dot2_f32_bf16 v57, v245, v11, v57
    v_dot2_f32_bf16 v57, v246, v12, v57
    v_dot2_f32_bf16 v57, v247, v13, v57
    s_waitcnt vmcnt(3)
    buffer_load_dwordx4 v[104:107], v8, s[44:47], s64 offen nt
    s_add_u32 s64, s64, s11
    v_dot2_f32_bf16 v58, v248, v10, 0
    v_dot2_f32_bf16 v58, v249, v11, v58
    v_dot2_f32_bf16 v58, v250, v12, v58
    v_dot2_f32_bf16 v58, v251, v13, v58
    v_dot2_f32_bf16 v59, v252, v10, 0
    v_dot2_f32_bf16 v59, v253, v11, v59
    v_dot2_f32_bf16 v59, v254, v12, v59
    v_dot2_f32_bf16 v59, v255, v13, v59
    v_add_f32_dpp v44, v44, v44 row_ror:8 row_mask:0xf bank_mask:0x3
    v_add_f32_dpp v45, v45, v45 row_ror:8 row_mask:0xf bank_mask:0x3
    v_add_f32_dpp v46, v46, v46 row_ror:8 row_mask:0xf bank_mask:0x3
    v_add_f32_dpp v47, v47, v47 row_ror:8 row_mask:0xf bank_mask:0x3
    v_add_f32_dpp v48, v48, v48 row_ror:8 row_mask:0xf bank_mask:0x3
    v_add_f32_dpp v49, v49, v49 row_ror:8 row_mask:0xf bank_mask:0x3
    v_add_f32_dpp v50, v50, v50 row_ror:8 row_mask:0xf bank_mask:0x3
    v_add_f32_dpp v51, v51, v51 row_ror:8 row_mask:0xf bank_mask:0x3
    v_add_f32_dpp v44, v52, v52 row_ror:8 row_mask:0xf bank_mask:0xc
    v_add_f32_dpp v45, v53, v53 row_ror:8 row_mask:0xf bank_mask:0xc
    v_add_f32_dpp v46, v54, v54 row_ror:8 row_mask:0xf bank_mask:0xc
    v_add_f32_dpp v47, v55, v55 row_ror:8 row_mask:0xf bank_mask:0xc
    s_waitcnt vmcnt(3)
    buffer_load_dwordx4 v[108:111], v8, s[44:47], s64 offen nt
    s_add_u32 s64, s64, s11
    v_add_f32_dpp v48, v56, v56 row_ror:8 row_mask:0xf bank_mask:0xc
    v_add_f32_dpp v49, v57, v57 row_ror:8 row_mask:0xf bank_mask:0xc
    v_add_f32_dpp v50, v58, v58 row_ror:8 row_mask:0xf bank_mask:0xc
    v_add_f32_dpp v51, v59, v59 row_ror:8 row_mask:0xf bank_mask:0xc
    v_add_f32_dpp v44, v44, v44 row_shl:4 row_mask:0xf bank_mask:0x5
    v_add_f32_dpp v45, v45, v45 row_shl:4 row_mask:0xf bank_mask:0x5
    v_add_f32_dpp v46, v46, v46 row_shl:4 row_mask:0xf bank_mask:0x5
    v_add_f32_dpp v47, v47, v47 row_shl:4 row_mask:0xf bank_mask:0x5
    v_add_f32_dpp v44, v48, v48 row_shr:4 row_mask:0xf bank_mask:0xa
    v_add_f32_dpp v45, v49, v49 row_shr:4 row_mask:0xf bank_mask:0xa
    v_add_f32_dpp v46, v50, v50 row_shr:4 row_mask:0xf bank_mask:0xa
    v_add_f32_dpp v47, v51, v51 row_shr:4 row_mask:0xf bank_mask:0xa
    v_add_f32_dpp v44, v44, v44 quad_perm:[2,3,0,1] row_mask:0xf bank_mask:0xf
    v_add_f32_dpp v45, v45, v45 quad_perm:[2,3,0,1] row_mask:0xf bank_mask:0xf
    v_add_f32_dpp v46, v46, v46 quad_perm:[2,3,0,1] row_mask:0xf bank_mask:0xf
    v_add_f32_dpp v47, v47, v47 quad_perm:[2,3,0,1] row_mask:0xf bank_mask:0xf
    v_add_f32_dpp v44, v44, v44 quad_perm:[1,0,3,2] row_mask:0xf bank_mask:0xf
    v_add_f32_dpp v45, v45, v45 quad_perm:[1,0,3,2] row_mask:0xf bank_mask:0xf
    v_add_f32_dpp v46, v46, v46 quad_perm:[1,0,3,2] row_mask:0xf bank_mask:0xf
    v_add_f32_dpp v47, v47, v47 quad_perm:[1,0,3,2] row_mask:0xf bank_mask:0xf
    v_cndmask_b32 v44, v44, v45, s[72:73]
    v_cndmask_b32 v44, v44, v46, s[74:75]
    v_cndmask_b32 v44, v44, v47, s[76:77]
    v_cvt_pk_bf16_f32 v44, v44, v44
    s_waitcnt vmcnt(3)
    buffer_load_dwordx4 v[112:115], v8, s[44:47], s64 offen nt
    s_add_u32 s64, s64, s11
    v_and_b32 v44, 0xffff0000, v44
    v_mul_f32 v44, s69, v44
    v_cvt_pk_bf16_f32 v38, v44, v44
    v_and_b32 v38, 0xffff0000, v38
    v_dot2_f32_bf16 v44, v64, v10, 0
    v_dot2_f32_bf16 v44, v65, v11, v44
    v_dot2_f32_bf16 v44, v66, v12, v44
    v_dot2_f32_bf16 v44, v67, v13, v44
    v_dot2_f32_bf16 v45, v68, v10, 0
    v_dot2_f32_bf16 v45, v69, v11, v45
    v_dot2_f32_bf16 v45, v70, v12, v45
    v_dot2_f32_bf16 v45, v71, v13, v45
    v_dot2_f32_bf16 v46, v72, v10, 0
    v_dot2_f32_bf16 v46, v73, v11, v46
    v_dot2_f32_bf16 v46, v74, v12, v46
    v_dot2_f32_bf16 v46, v75, v13, v46
    v_dot2_f32_bf16 v47, v76, v10, 0
    v_dot2_f32_bf16 v47, v77, v11, v47
    v_dot2_f32_bf16 v47, v78, v12, v47
    v_dot2_f32_bf16 v47, v79, v13, v47
    s_waitcnt vmcnt(3)
    buffer_load_dwordx4 v[116:119], v8, s[44:47], s64 offen nt
    s_add_u32 s64, s64, s11
    v_dot2_f32_bf16 v48, v80, v10, 0
    v_dot2_f32_bf16 v48, v81, v11, v48
    v_dot2_f32_bf16 v48, v82, v12, v48
    v_dot2_f32_bf16 v48, v83, v13, v48
    v_dot2_f32_bf16 v49, v84, v10, 0
    v_dot2_f32_bf16 v49, v85, v11, v49
    v_dot2_f32_bf16 v49, v86, v12, v49
    v_dot2_f32_bf16 v49, v87, v13, v49
    v_dot2_f32_bf16 v50, v88, v10, 0
    v_dot2_f32_bf16 v50, v89, v11, v50
    v_dot2_f32_bf16 v50, v90, v12, v50
    v_dot2_f32_bf16 v50, v91, v13, v50
    v_dot2_f32_bf16 v51, v92, v10, 0
    v_dot2_f32_bf16 v51, v93, v11, v51
    v_dot2_f32_bf16 v51, v94, v12, v51
    v_dot2_f32_bf16 v51, v95, v13, v51
    s_waitcnt vmcnt(3)
    buffer_load_dwordx4 v[120:123], v8, s[44:47], s64 offen nt
    s_add_u32 s64, s64, s11
    v_dot2_f32_bf16 v52, v96, v10, 0
    v_dot2_f32_bf16 v52, v97, v11, v52
    v_dot2_f32_bf16 v52, v98, v12, v52
    v_dot2_f32_bf16 v52, v99, v13, v52
    v_dot2_f32_bf16 v53, v100, v10, 0
    v_dot2_f32_bf16 v53, v101, v11, v53
    v_dot2_f32_bf16 v53, v102, v12, v53
    v_dot2_f32_bf16 v53, v103, v13, v53
    v_dot2_f32_bf16 v54, v104, v10, 0
    v_dot2_f32_bf16 v54, v105, v11, v54
    v_dot2_f32_bf16 v54, v106, v12, v54
    v_dot2_f32_bf16 v54, v107, v13, v54
    s_waitcnt vmcnt(3)
    buffer_load_dwordx4 v[124:127], v8, s[44:47], s64 offen nt
    s_add_u32 s64, s64, s11
    v_dot2_f32_bf16 v55, v108, v10, 0
    v_dot2_f32_bf16 v55, v109, v11, v55
    v_dot2_f32_bf16 v55, v110, v12, v55
    v_dot2_f32_bf16 v55, v111, v13, v55
    s_waitcnt vmcnt(3)
    buffer_load_dwordx4 v[128:131], v8, s[44:47], s64 offen nt
    s_add_u32 s64, s64, s11
    v_dot2_f32_bf16 v56, v112, v10, 0
    v_dot2_f32_bf16 v56, v113, v11, v56
    v_dot2_f32_bf16 v56, v114, v12, v56
    v_dot2_f32_bf16 v56, v115, v13, v56
    s_waitcnt vmcnt(3)
    buffer_load_dwordx4 v[132:135], v8, s[44:47], s64 offen nt
    s_add_u32 s64, s64, s11
    v_dot2_f32_bf16 v57, v116, v10, 0
    v_dot2_f32_bf16 v57, v117, v11, v57
    v_dot2_f32_bf16 v57, v118, v12, v57
    v_dot2_f32_bf16 v57, v119, v13, v57
    s_waitcnt vmcnt(3)
    buffer_load_dwordx4 v[136:139], v8, s[44:47], s64 offen nt
    s_add_u32 s64, s64, s11
    v_dot2_f32_bf16 v58, v120, v10, 0
    v_dot2_f32_bf16 v58, v121, v11, v58
    v_dot2_f32_bf16 v58, v122, v12, v58
    v_dot2_f32_bf16 v58, v123, v13, v58
    s_waitcnt vmcnt(3)
    buffer_load_dwordx4 v[140:143], v8, s[44:47], s64 offen nt
    s_add_u32 s64, s64, s11
    v_dot2_f32_bf16 v59, v124, v10, 0
    v_dot2_f32_bf16 v59, v125, v11, v59
    v_dot2_f32_bf16 v59, v126, v12, v59
    v_dot2_f32_bf16 v59, v127, v13, v59
    v_add_f32_dpp v44, v44, v44 row_ror:8 row_mask:0xf bank_mask:0x3
    v_add_f32_dpp v45, v45, v45 row_ror:8 row_mask:0xf bank_mask:0x3
    v_add_f32_dpp v46, v46, v46 row_ror:8 row_mask:0xf bank_mask:0x3
    v_add_f32_dpp v47, v47, v47 row_ror:8 row_mask:0xf bank_mask:0x3
    v_add_f32_dpp v48, v48, v48 row_ror:8 row_mask:0xf bank_mask:0x3
    v_add_f32_dpp v49, v49, v49 row_ror:8 row_mask:0xf bank_mask:0x3
    v_add_f32_dpp v50, v50, v50 row_ror:8 row_mask:0xf bank_mask:0x3
    v_add_f32_dpp v51, v51, v51 row_ror:8 row_mask:0xf bank_mask:0x3
    v_add_f32_dpp v44, v52, v52 row_ror:8 row_mask:0xf bank_mask:0xc
    v_add_f32_dpp v45, v53, v53 row_ror:8 row_mask:0xf bank_mask:0xc
    v_add_f32_dpp v46, v54, v54 row_ror:8 row_mask:0xf bank_mask:0xc
    v_add_f32_dpp v47, v55, v55 row_ror:8 row_mask:0xf bank_mask:0xc
    v_add_f32_dpp v48, v56, v56 row_ror:8 row_mask:0xf bank_mask:0xc
    v_add_f32_dpp v49, v57, v57 row_ror:8 row_mask:0xf bank_mask:0xc
    v_add_f32_dpp v50, v58, v58 row_ror:8 row_mask:0xf bank_mask:0xc
    v_add_f32_dpp v51, v59, v59 row_ror:8 row_mask:0xf bank_mask:0xc
    v_add_f32_dpp v44, v44, v44 row_shl:4 row_mask:0xf bank_mask:0x5
    v_add_f32_dpp v45, v45, v45 row_shl:4 row_mask:0xf bank_mask:0x5
    s_waitcnt vmcnt(3)
    buffer_load_dwordx4 v[144:147], v8, s[44:47], s64 offen nt
    s_add_u32 s64, s64, s11
    v_add_f32_dpp v46, v46, v46 row_shl:4 row_mask:0xf bank_mask:0x5
    v_add_f32_dpp v47, v47, v47 row_shl:4 row_mask:0xf bank_mask:0x5
    v_add_f32_dpp v44, v48, v48 row_shr:4 row_mask:0xf bank_mask:0xa
    v_add_f32_dpp v45, v49, v49 row_shr:4 row_mask:0xf bank_mask:0xa
    v_add_f32_dpp v46, v50, v50 row_shr:4 row_mask:0xf bank_mask:0xa
    v_add_f32_dpp v47, v51, v51 row_shr:4 row_mask:0xf bank_mask:0xa
    v_add_f32_dpp v44, v44, v44 quad_perm:[2,3,0,1] row_mask:0xf bank_mask:0xf
    v_add_f32_dpp v45, v45, v45 quad_perm:[2,3,0,1] row_mask:0xf bank_mask:0xf
    v_add_f32_dpp v46, v46, v46 quad_perm:[2,3,0,1] row_mask:0xf bank_mask:0xf
    v_add_f32_dpp v47, v47, v47 quad_perm:[2,3,0,1] row_mask:0xf bank_mask:0xf
    v_add_f32_dpp v44, v44, v44 quad_perm:[1,0,3,2] row_mask:0xf bank_mask:0xf
    v_add_f32_dpp v45, v45, v45 quad_perm:[1,0,3,2] row_mask:0xf bank_mask:0xf
    v_add_f32_dpp v46, v46, v46 quad_perm:[1,0,3,2] row_mask:0xf bank_mask:0xf
    v_add_f32_dpp v47, v47, v47 quad_perm:[1,0,3,2] row_mask:0xf bank_mask:0xf
    v_cndmask_b32 v44, v44, v45, s[72:73]
    v_cndmask_b32 v44, v44, v46, s[74:75]
    v_cndmask_b32 v44, v44, v47, s[76:77]
    v_cvt_pk_bf16_f32 v44, v44, v44
    v_and_b32 v44, 0xffff0000, v44
    v_mul_f32 v44, s69, v44
    v_cvt_pk_bf16_f32 v39, v44, v44
    v_and_b32 v39, 0xffff0000, v39
    v_dot2_f32_bf16 v44, v128, v10, 0
    v_dot2_f32_bf16 v44, v129, v11, v44
    v_dot2_f32_bf16 v44, v130, v12, v44
    v_dot2_f32_bf16 v44, v131, v13, v44
    s_waitcnt vmcnt(3)
    buffer_load_dwordx4 v[148:151], v8, s[44:47], s64 offen nt
    s_add_u32 s64, s64, s11
    v_dot2_f32_bf16 v45, v132, v10, 0
    v_dot2_f32_bf16 v45, v133, v11, v45
    v_dot2_f32_bf16 v45, v134, v12, v45
    v_dot2_f32_bf16 v45, v135, v13, v45
    s_waitcnt vmcnt(3)
    buffer_load_dwordx4 v[152:155], v8, s[44:47], s64 offen nt
    s_add_u32 s64, s64, s11
    v_dot2_f32_bf16 v46, v136, v10, 0
    v_dot2_f32_bf16 v46, v137, v11, v46
    v_dot2_f32_bf16 v46, v138, v12, v46
    v_dot2_f32_bf16 v46, v139, v13, v46
    s_waitcnt vmcnt(3)
    buffer_load_dwordx4 v[156:159], v8, s[44:47], s64 offen nt
    s_add_u32 s64, s64, s11
    v_dot2_f32_bf16 v47, v140, v10, 0
    v_dot2_f32_bf16 v47, v141, v11, v47
    v_dot2_f32_bf16 v47, v142, v12, v47
    v_dot2_f32_bf16 v47, v143, v13, v47
    s_waitcnt vmcnt(3)
    buffer_load_dwordx4 v[160:163], v8, s[44:47], s64 offen nt
    s_add_u32 s64, s64, s11
    v_dot2_f32_bf16 v48, v144, v10, 0
    v_dot2_f32_bf16 v48, v145, v11, v48
    v_dot2_f32_bf16 v48, v146, v12, v48
    v_dot2_f32_bf16 v48, v147, v13, v48
    s_waitcnt vmcnt(3)
    buffer_load_dwordx4 v[164:167], v8, s[44:47], s64 offen nt
    s_add_u32 s64, s64, s11
    v_dot2_f32_bf16 v49, v148, v10, 0
    v_dot2_f32_bf16 v49, v149, v11, v49
    v_dot2_f32_bf16 v49, v150, v12, v49
    v_dot2_f32_bf16 v49, v151, v13, v49
    s_waitcnt vmcnt(3)
    buffer_load_dwordx4 v[168:171], v8, s[44:47], s64 offen nt
    s_add_u32 s64, s64, s11
    v_dot2_f32_bf16 v50, v152, v10, 0
    v_dot2_f32_bf16 v50, v153, v11, v50
    v_dot2_f32_bf16 v50, v154, v12, v50
    v_dot2_f32_bf16 v50, v155, v13, v50
    s_waitcnt vmcnt(3)
    buffer_load_dwordx4 v[172:175], v8, s[44:47], s64 offen nt
    s_add_u32 s64, s64, s11
    v_dot2_f32_bf16 v51, v156, v10, 0
    v_dot2_f32_bf16 v51, v157, v11, v51
    v_dot2_f32_bf16 v51, v158, v12, v51
    v_dot2_f32_bf16 v51, v159, v13, v51
    s_waitcnt vmcnt(3)
    buffer_load_dwordx4 v[176:179], v8, s[44:47], s64 offen nt
    s_add_u32 s64, s64, s11
    v_dot2_f32_bf16 v52, v160, v10, 0
    v_dot2_f32_bf16 v52, v161, v11, v52
    v_dot2_f32_bf16 v52, v162, v12, v52
    v_dot2_f32_bf16 v52, v163, v13, v52
    s_waitcnt vmcnt(3)
    buffer_load_dwordx4 v[180:183], v8, s[44:47], s64 offen nt
    s_add_u32 s64, s64, s11
    v_dot2_f32_bf16 v53, v164, v10, 0
    v_dot2_f32_bf16 v53, v165, v11, v53
    v_dot2_f32_bf16 v53, v166, v12, v53
    v_dot2_f32_bf16 v53, v167, v13, v53
    s_waitcnt vmcnt(3)
    buffer_load_dwordx4 v[184:187], v8, s[44:47], s64 offen nt
    s_add_u32 s64, s64, s11
    v_dot2_f32_bf16 v54, v168, v10, 0
    v_dot2_f32_bf16 v54, v169, v11, v54
    v_dot2_f32_bf16 v54, v170, v12, v54
    v_dot2_f32_bf16 v54, v171, v13, v54
    s_waitcnt vmcnt(3)
    buffer_load_dwordx4 v[188:191], v8, s[44:47], s64 offen nt
    s_add_u32 s64, s64, s11
    v_dot2_f32_bf16 v55, v172, v10, 0
    v_dot2_f32_bf16 v55, v173, v11, v55
    v_dot2_f32_bf16 v55, v174, v12, v55
    v_dot2_f32_bf16 v55, v175, v13, v55
    s_waitcnt vmcnt(3)
    buffer_load_dwordx4 v[192:195], v8, s[44:47], s64 offen nt
    s_add_u32 s64, s64, s11
    v_dot2_f32_bf16 v56, v176, v10, 0
    v_dot2_f32_bf16 v56, v177, v11, v56
    v_dot2_f32_bf16 v56, v178, v12, v56
    v_dot2_f32_bf16 v56, v179, v13, v56
    s_waitcnt vmcnt(3)
    buffer_load_dwordx4 v[196:199], v8, s[44:47], s64 offen nt
    s_add_u32 s64, s64, s11
    v_dot2_f32_bf16 v57, v180, v10, 0
    v_dot2_f32_bf16 v57, v181, v11, v57
    v_dot2_f32_bf16 v57, v182, v12, v57
    v_dot2_f32_bf16 v57, v183, v13, v57
    s_waitcnt vmcnt(3)
    buffer_load_dwordx4 v[200:203], v8, s[44:47], s64 offen nt
    s_add_u32 s64, s64, s11
    v_dot2_f32_bf16 v58, v184, v10, 0
    v_dot2_f32_bf16 v58, v185, v11, v58
    v_dot2_f32_bf16 v58, v186, v12, v58
    v_dot2_f32_bf16 v58, v187, v13, v58
    s_waitcnt vmcnt(3)
    buffer_load_dwordx4 v[204:207], v8, s[44:47], s64 offen nt
    s_add_u32 s64, s64, s11
    v_dot2_f32_bf16 v59, v188, v10, 0
    v_dot2_f32_bf16 v59, v189, v11, v59
    v_dot2_f32_bf16 v59, v190, v12, v59
    v_dot2_f32_bf16 v59, v191, v13, v59
    v_add_f32_dpp v44, v44, v44 row_ror:8 row_mask:0xf bank_mask:0x3
    v_add_f32_dpp v45, v45, v45 row_ror:8 row_mask:0xf bank_mask:0x3
    v_add_f32_dpp v46, v46, v46 row_ror:8 row_mask:0xf bank_mask:0x3
    v_add_f32_dpp v47, v47, v47 row_ror:8 row_mask:0xf bank_mask:0x3
    v_add_f32_dpp v48, v48, v48 row_ror:8 row_mask:0xf bank_mask:0x3
    v_add_f32_dpp v49, v49, v49 row_ror:8 row_mask:0xf bank_mask:0x3
    v_add_f32_dpp v50, v50, v50 row_ror:8 row_mask:0xf bank_mask:0x3
    v_add_f32_dpp v51, v51, v51 row_ror:8 row_mask:0xf bank_mask:0x3
    v_add_f32_dpp v44, v52, v52 row_ror:8 row_mask:0xf bank_mask:0xc
    v_add_f32_dpp v45, v53, v53 row_ror:8 row_mask:0xf bank_mask:0xc
    v_add_f32_dpp v46, v54, v54 row_ror:8 row_mask:0xf bank_mask:0xc
    v_add_f32_dpp v47, v55, v55 row_ror:8 row_mask:0xf bank_mask:0xc
    v_add_f32_dpp v48, v56, v56 row_ror:8 row_mask:0xf bank_mask:0xc
    v_add_f32_dpp v49, v57, v57 row_ror:8 row_mask:0xf bank_mask:0xc
    v_add_f32_dpp v50, v58, v58 row_ror:8 row_mask:0xf bank_mask:0xc
    v_add_f32_dpp v51, v59, v59 row_ror:8 row_mask:0xf bank_mask:0xc
    v_add_f32_dpp v44, v44, v44 row_shl:4 row_mask:0xf bank_mask:0x5
    v_add_f32_dpp v45, v45, v45 row_shl:4 row_mask:0xf bank_mask:0x5
    s_waitcnt vmcnt(3)
    buffer_load_dwordx4 v[208:211], v8, s[44:47], s64 offen nt
    s_add_u32 s64, s64, s11
    v_add_f32_dpp v46, v46, v46 row_shl:4 row_mask:0xf bank_mask:0x5
    v_add_f32_dpp v47, v47, v47 row_shl:4 row_mask:0xf bank_mask:0x5
    v_add_f32_dpp v44, v48, v48 row_shr:4 row_mask:0xf bank_mask:0xa
    v_add_f32_dpp v45, v49, v49 row_shr:4 row_mask:0xf bank_mask:0xa
    v_add_f32_dpp v46, v50, v50 row_shr:4 row_mask:0xf bank_mask:0xa
    v_add_f32_dpp v47, v51, v51 row_shr:4 row_mask:0xf bank_mask:0xa
    v_add_f32_dpp v44, v44, v44 quad_perm:[2,3,0,1] row_mask:0xf bank_mask:0xf
    v_add_f32_dpp v45, v45, v45 quad_perm:[2,3,0,1] row_mask:0xf bank_mask:0xf
    v_add_f32_dpp v46, v46, v46 quad_perm:[2,3,0,1] row_mask:0xf bank_mask:0xf
    v_add_f32_dpp v47, v47, v47 quad_perm:[2,3,0,1] row_mask:0xf bank_mask:0xf
    v_add_f32_dpp v44, v44, v44 quad_perm:[1,0,3,2] row_mask:0xf bank_mask:0xf
    v_add_f32_dpp v45, v45, v45 quad_perm:[1,0,3,2] row_mask:0xf bank_mask:0xf
    v_add_f32_dpp v46, v46, v46 quad_perm:[1,0,3,2] row_mask:0xf bank_mask:0xf
    v_add_f32_dpp v47, v47, v47 quad_perm:[1,0,3,2] row_mask:0xf bank_mask:0xf
    v_cndmask_b32 v44, v44, v45, s[72:73]
    v_cndmask_b32 v44, v44, v46, s[74:75]
    v_cndmask_b32 v44, v44, v47, s[76:77]
    v_cvt_pk_bf16_f32 v44, v44, v44
    v_and_b32 v44, 0xffff0000, v44
    v_mul_f32 v44, s69, v44
    v_cvt_pk_bf16_f32 v40, v44, v44
    v_and_b32 v40, 0xffff0000, v40
    v_dot2_f32_bf16 v44, v192, v10, 0
    v_dot2_f32_bf16 v44, v193, v11, v44
    v_dot2_f32_bf16 v44, v194, v12, v44
    v_dot2_f32_bf16 v44, v195, v13, v44
    s_waitcnt vmcnt(3)
    buffer_load_dwordx4 v[212:215], v8, s[44:47], s64 offen nt
    s_add_u32 s64, s64, s11
    v_dot2_f32_bf16 v45, v196, v10, 0
    v_dot2_f32_bf16 v45, v197, v11, v45
    v_dot2_f32_bf16 v45, v198, v12, v45
    v_dot2_f32_bf16 v45, v199, v13, v45
    s_waitcnt vmcnt(3)
    s_mov_b32 s44, s70
    s_mov_b32 s45, s71
    s_mov_b32 s64, 0
    buffer_load_dwordx4 v[216:219], v8, s[44:47], s64 offen nt
    s_add_u32 s64, s64, s11
    v_dot2_f32_bf16 v46, v200, v10, 0
    v_dot2_f32_bf16 v46, v201, v11, v46
    v_dot2_f32_bf16 v46, v202, v12, v46
    v_dot2_f32_bf16 v46, v203, v13, v46
    s_waitcnt vmcnt(3)
    buffer_load_dwordx4 v[220:223], v8, s[44:47], s64 offen nt
    s_add_u32 s64, s64, s11
    v_dot2_f32_bf16 v47, v204, v10, 0
    v_dot2_f32_bf16 v47, v205, v11, v47
    v_dot2_f32_bf16 v47, v206, v12, v47
    v_dot2_f32_bf16 v47, v207, v13, v47
    s_waitcnt vmcnt(3)
    buffer_load_dwordx4 v[224:227], v8, s[44:47], s64 offen nt
    s_add_u32 s64, s64, s11
    v_dot2_f32_bf16 v48, v208, v10, 0
    v_dot2_f32_bf16 v48, v209, v11, v48
    v_dot2_f32_bf16 v48, v210, v12, v48
    v_dot2_f32_bf16 v48, v211, v13, v48
    s_waitcnt vmcnt(3)
    buffer_load_dwordx4 v[228:231], v8, s[44:47], s64 offen nt
    s_add_u32 s64, s64, s11
    v_dot2_f32_bf16 v49, v212, v10, 0
    v_dot2_f32_bf16 v49, v213, v11, v49
    v_dot2_f32_bf16 v49, v214, v12, v49
    v_dot2_f32_bf16 v49, v215, v13, v49
    v_add_f32_dpp v44, v44, v44 row_ror:8 row_mask:0xf bank_mask:0x3
    v_add_f32_dpp v45, v45, v45 row_ror:8 row_mask:0xf bank_mask:0x3
    v_add_f32_dpp v46, v46, v46 row_ror:8 row_mask:0xf bank_mask:0x3
    v_add_f32_dpp v47, v47, v47 row_ror:8 row_mask:0xf bank_mask:0x3
    v_add_f32_dpp v48, v48, v48 row_ror:8 row_mask:0xf bank_mask:0x3
    v_add_f32_dpp v49, v49, v49 row_ror:8 row_mask:0xf bank_mask:0x3
    v_add_f32_dpp v50, v50, v50 row_ror:8 row_mask:0xf bank_mask:0x3
    v_add_f32_dpp v51, v51, v51 row_ror:8 row_mask:0xf bank_mask:0x3
    v_add_f32_dpp v44, v44, v44 row_shl:4 row_mask:0xf bank_mask:0x5
    v_add_f32_dpp v45, v45, v45 row_shl:4 row_mask:0xf bank_mask:0x5
    v_add_f32_dpp v46, v46, v46 row_shl:4 row_mask:0xf bank_mask:0x5
    v_add_f32_dpp v47, v47, v47 row_shl:4 row_mask:0xf bank_mask:0x5
    v_add_f32_dpp v44, v48, v48 row_shr:4 row_mask:0xf bank_mask:0xa
    v_add_f32_dpp v45, v49, v49 row_shr:4 row_mask:0xf bank_mask:0xa
    v_add_f32_dpp v46, v50, v50 row_shr:4 row_mask:0xf bank_mask:0xa
    v_add_f32_dpp v47, v51, v51 row_shr:4 row_mask:0xf bank_mask:0xa
    v_add_f32_dpp v44, v44, v44 quad_perm:[2,3,0,1] row_mask:0xf bank_mask:0xf
    v_add_f32_dpp v45, v45, v45 quad_perm:[2,3,0,1] row_mask:0xf bank_mask:0xf
    s_waitcnt vmcnt(3)
    buffer_load_dwordx4 v[232:235], v8, s[44:47], s64 offen nt
    s_add_u32 s64, s64, s11
    v_add_f32_dpp v46, v46, v46 quad_perm:[2,3,0,1] row_mask:0xf bank_mask:0xf
    v_add_f32_dpp v47, v47, v47 quad_perm:[2,3,0,1] row_mask:0xf bank_mask:0xf
    v_add_f32_dpp v44, v44, v44 quad_perm:[1,0,3,2] row_mask:0xf bank_mask:0xf
    v_add_f32_dpp v45, v45, v45 quad_perm:[1,0,3,2] row_mask:0xf bank_mask:0xf
    v_add_f32_dpp v46, v46, v46 quad_perm:[1,0,3,2] row_mask:0xf bank_mask:0xf
    v_add_f32_dpp v47, v47, v47 quad_perm:[1,0,3,2] row_mask:0xf bank_mask:0xf
    v_cndmask_b32 v44, v44, v45, s[72:73]
    v_cndmask_b32 v44, v44, v46, s[74:75]
    v_cndmask_b32 v44, v44, v47, s[76:77]
    v_cvt_pk_bf16_f32 v44, v44, v44
    v_and_b32 v44, 0xffff0000, v44
    v_mul_f32 v44, s69, v44
    v_cvt_pk_bf16_f32 v41, v44, v44
    v_and_b32 v41, 0xffff0000, v41
    s_sub_u32 s66, s13, s3
    s_sub_u32 s66, s66, 640
    v_lshlrev_b32 v28, 3, v3
    v_cmp_gt_u32 vcc, s66, v28
    v_mov_b32 v28, 0xff800000
    s_nop 0
    v_cndmask_b32 v41, v28, v41, vcc
    v_max3_f32 v26, v36, v37, v38
    v_max3_f32 v26, v26, v39, v40
    v_max_f32 v26, v26, v41
    s_waitcnt vmcnt(3)
    buffer_load_dwordx4 v[236:239], v8, s[44:47], s64 offen nt
    s_add_u32 s64, s64, s11
    v_max_f32_dpp v26, v26, v26 quad_perm:[1,0,3,2] row_mask:0xf bank_mask:0xf
    s_nop 1
    v_max_f32_dpp v26, v26, v26 quad_perm:[2,3,0,1] row_mask:0xf bank_mask:0xf
    s_nop 1
    v_max_f32_dpp v26, v26, v26 row_half_mirror row_mask:0xf bank_mask:0xf
    s_nop 1
    v_max_f32_dpp v26, v26, v26 row_mirror row_mask:0xf bank_mask:0xf
    v_mov_b32 v28, v26
    s_nop 1
    v_permlane16_swap_b32 v26, v28
    v_max_f32 v26, v26, v28
    v_mov_b32 v28, v26
    s_nop 1
    v_permlane32_swap_b32 v26, v28
    v_max_f32 v26, v26, v28
    s_mov_b32 s69, 0x3fb8aa3b
    v_sub_f32 v36, v36, v26
    v_sub_f32 v37, v37, v26
    v_sub_f32 v38, v38, v26
    v_sub_f32 v39, v39, v26
    v_sub_f32 v40, v40, v26
    v_sub_f32 v41, v41, v26
    v_mul_f32 v36, s69, v36
    v_mul_f32 v37, s69, v37
    v_mul_f32 v38, s69, v38
    v_mul_f32 v39, s69, v39
    v_mul_f32 v40, s69, v40
    v_mul_f32 v41, s69, v41
    v_exp_f32 v36, v36
    s_waitcnt vmcnt(3)
    buffer_load_dwordx4 v[240:243], v8, s[44:47], s64 offen nt
    s_add_u32 s64, s64, s11
    v_exp_f32 v37, v37
    v_exp_f32 v38, v38
    v_exp_f32 v39, v39
    v_exp_f32 v40, v40
    v_exp_f32 v41, v41
    v_add_f32 v27, v36, v37
    v_add_f32 v27, v27, v38
    v_add_f32 v27, v27, v39
    v_add_f32 v27, v27, v40
    v_add_f32 v27, v27, v41
    v_cvt_pk_bf16_f32 v36, v36, v36
    v_cvt_pk_bf16_f32 v37, v37, v37
    v_cvt_pk_bf16_f32 v38, v38, v38
    v_cvt_pk_bf16_f32 v39, v39, v39
    v_cvt_pk_bf16_f32 v40, v40, v40
    v_cvt_pk_bf16_f32 v41, v41, v41
    v_add_f32_dpp v27, v27, v27 quad_perm:[1,0,3,2] row_mask:0xf bank_mask:0xf
    s_nop 1
    v_add_f32_dpp v27, v27, v27 quad_perm:[2,3,0,1] row_mask:0xf bank_mask:0xf
    s_nop 1
    v_add_f32_dpp v27, v27, v27 row_half_mirror row_mask:0xf bank_mask:0xf
    s_nop 1
    v_add_f32_dpp v27, v27, v27 row_mirror row_mask:0xf bank_mask:0xf
    v_mov_b32 v28, v27
    s_nop 1
    v_permlane16_swap_b32 v27, v28
    v_add_f32 v27, v27, v28
    v_mov_b32 v28, v27
    s_waitcnt vmcnt(3)
    buffer_load_dwordx4 v[244:247], v8, s[44:47], s64 offen nt
    s_add_u32 s64, s64, s11
    v_permlane32_swap_b32 v27, v28
    v_add_f32 v27, v27, v28
    s_lshl_b32 s66, s3, 3
    v_mov_b32 v28, s66
    ds_write_b64 v28, v[26:27] offset:256
    v_lshlrev_b32 v28, 5, v3
    v_lshl_add_u32 v28, v2, 4, v28
    s_lshl_b32 s66, s3, 9
    v_add_u32 v28, s66, v28
    v_mov_b32 v31, 1
    v_and_b32 v35, 7, v1
    v_lshlrev_b32 v35, 3, v35
    s_lshl_b32 s66, s9, 9
    s_lshl_b32 s67, s6, 2
    s_add_u32 s67, s67, s8
    s_lshl_b32 s67, s67, 4
    s_add_u32 s67, s67, 98304
    v_and_b32_dpp v18, v36, v4 row_newbcast:0 row_mask:0xf bank_mask:0xf
    v_and_b32_dpp v19, v36, v5 row_newbcast:0 row_mask:0xf bank_mask:0xf
    v_and_b32_dpp v20, v36, v6 row_newbcast:0 row_mask:0xf bank_mask:0xf
    v_and_b32_dpp v21, v36, v7 row_newbcast:0 row_mask:0xf bank_mask:0xf
    s_nop 1
    v_mfma_f32_16x16x32_bf16 v[14:17], v[18:21], v[216:219], 0
    v_and_b32_dpp v22, v36, v4 row_newbcast:1 row_mask:0xf bank_mask:0xf
    v_and_b32_dpp v23, v36, v5 row_newbcast:1 row_mask:0xf bank_mask:0xf
    v_and_b32_dpp v24, v36, v6 row_newbcast:1 row_mask:0xf bank_mask:0xf
    v_and_b32_dpp v25, v36, v7 row_newbcast:1 row_mask:0xf bank_mask:0xf
    s_waitcnt vmcnt(3)
    buffer_load_dwordx4 v[248:251], v8, s[44:47], s64 offen nt
    s_add_u32 s64, s64, s11
    v_mfma_f32_16x16x32_bf16 v[14:17], v[22:25], v[220:223], v[14:17]
    v_and_b32_dpp v18, v36, v4 row_newbcast:2 row_mask:0xf bank_mask:0xf
    v_and_b32_dpp v19, v36, v5 row_newbcast:2 row_mask:0xf bank_mask:0xf
    v_and_b32_dpp v20, v36, v6 row_newbcast:2 row_mask:0xf bank_mask:0xf
    v_and_b32_dpp v21, v36, v7 row_newbcast:2 row_mask:0xf bank_mask:0xf
    s_nop 1
    v_mfma_f32_16x16x32_bf16 v[14:17], v[18:21], v[224:227], v[14:17]
    v_and_b32_dpp v22, v36, v4 row_newbcast:3 row_mask:0xf bank_mask:0xf
    v_and_b32_dpp v23, v36, v5 row_newbcast:3 row_mask:0xf bank_mask:0xf
    v_and_b32_dpp v24, v36, v6 row_newbcast:3 row_mask:0xf bank_mask:0xf
    v_and_b32_dpp v25, v36, v7 row_newbcast:3 row_mask:0xf bank_mask:0xf
    s_nop 1
    v_mfma_f32_16x16x32_bf16 v[14:17], v[22:25], v[228:231], v[14:17]
    v_and_b32_dpp v18, v36, v4 row_newbcast:4 row_mask:0xf bank_mask:0xf
    v_and_b32_dpp v19, v36, v5 row_newbcast:4 row_mask:0xf bank_mask:0xf
    v_and_b32_dpp v20, v36, v6 row_newbcast:4 row_mask:0xf bank_mask:0xf
    v_and_b32_dpp v21, v36, v7 row_newbcast:4 row_mask:0xf bank_mask:0xf
    s_nop 1
    v_mfma_f32_16x16x32_bf16 v[14:17], v[18:21], v[232:235], v[14:17]
    v_and_b32_dpp v22, v36, v4 row_newbcast:5 row_mask:0xf bank_mask:0xf
    v_and_b32_dpp v23, v36, v5 row_newbcast:5 row_mask:0xf bank_mask:0xf
    v_and_b32_dpp v24, v36, v6 row_newbcast:5 row_mask:0xf bank_mask:0xf
    v_and_b32_dpp v25, v36, v7 row_newbcast:5 row_mask:0xf bank_mask:0xf
    s_waitcnt vmcnt(3)
    buffer_load_dwordx4 v[252:255], v8, s[44:47], s64 offen nt
    s_add_u32 s64, s64, s11
    v_mfma_f32_16x16x32_bf16 v[14:17], v[22:25], v[236:239], v[14:17]
    v_and_b32_dpp v18, v36, v4 row_newbcast:6 row_mask:0xf bank_mask:0xf
    v_and_b32_dpp v19, v36, v5 row_newbcast:6 row_mask:0xf bank_mask:0xf
    v_and_b32_dpp v20, v36, v6 row_newbcast:6 row_mask:0xf bank_mask:0xf
    v_and_b32_dpp v21, v36, v7 row_newbcast:6 row_mask:0xf bank_mask:0xf
    s_waitcnt vmcnt(3)
    buffer_load_dwordx4 v[64:67], v8, s[44:47], s64 offen nt
    s_add_u32 s64, s64, s11
    v_mfma_f32_16x16x32_bf16 v[14:17], v[18:21], v[240:243], v[14:17]
    v_and_b32_dpp v22, v36, v4 row_newbcast:7 row_mask:0xf bank_mask:0xf
    v_and_b32_dpp v23, v36, v5 row_newbcast:7 row_mask:0xf bank_mask:0xf
    v_and_b32_dpp v24, v36, v6 row_newbcast:7 row_mask:0xf bank_mask:0xf
    v_and_b32_dpp v25, v36, v7 row_newbcast:7 row_mask:0xf bank_mask:0xf
    s_waitcnt vmcnt(3)
    buffer_load_dwordx4 v[68:71], v8, s[44:47], s64 offen nt
    s_add_u32 s64, s64, s11
    v_mfma_f32_16x16x32_bf16 v[14:17], v[22:25], v[244:247], v[14:17]
    v_and_b32_dpp v18, v36, v4 row_newbcast:8 row_mask:0xf bank_mask:0xf
    v_and_b32_dpp v19, v36, v5 row_newbcast:8 row_mask:0xf bank_mask:0xf
    v_and_b32_dpp v20, v36, v6 row_newbcast:8 row_mask:0xf bank_mask:0xf
    v_and_b32_dpp v21, v36, v7 row_newbcast:8 row_mask:0xf bank_mask:0xf
    s_waitcnt vmcnt(3)
    buffer_load_dwordx4 v[72:75], v8, s[44:47], s64 offen nt
    s_add_u32 s64, s64, s11
    v_mfma_f32_16x16x32_bf16 v[14:17], v[18:21], v[248:251], v[14:17]
    v_and_b32_dpp v22, v36, v4 row_newbcast:9 row_mask:0xf bank_mask:0xf
    v_and_b32_dpp v23, v36, v5 row_newbcast:9 row_mask:0xf bank_mask:0xf
    v_and_b32_dpp v24, v36, v6 row_newbcast:9 row_mask:0xf bank_mask:0xf
    v_and_b32_dpp v25, v36, v7 row_newbcast:9 row_mask:0xf bank_mask:0xf
    s_waitcnt vmcnt(3)
    buffer_load_dwordx4 v[76:79], v8, s[44:47], s64 offen nt
    s_add_u32 s64, s64, s11
    v_mfma_f32_16x16x32_bf16 v[14:17], v[22:25], v[252:255], v[14:17]
    v_and_b32_dpp v18, v36, v4 row_newbcast:10 row_mask:0xf bank_mask:0xf
    v_and_b32_dpp v19, v36, v5 row_newbcast:10 row_mask:0xf bank_mask:0xf
    v_and_b32_dpp v20, v36, v6 row_newbcast:10 row_mask:0xf bank_mask:0xf
    v_and_b32_dpp v21, v36, v7 row_newbcast:10 row_mask:0xf bank_mask:0xf
    s_waitcnt vmcnt(3)
    buffer_load_dwordx4 v[80:83], v8, s[44:47], s64 offen nt
    s_add_u32 s64, s64, s11
    v_mfma_f32_16x16x32_bf16 v[14:17], v[18:21], v[64:67], v[14:17]
    v_and_b32_dpp v22, v36, v4 row_newbcast:11 row_mask:0xf bank_mask:0xf
    v_and_b32_dpp v23, v36, v5 row_newbcast:11 row_mask:0xf bank_mask:0xf
    v_and_b32_dpp v24, v36, v6 row_newbcast:11 row_mask:0xf bank_mask:0xf
    v_and_b32_dpp v25, v36, v7 row_newbcast:11 row_mask:0xf bank_mask:0xf
    s_waitcnt vmcnt(3)
    buffer_load_dwordx4 v[84:87], v8, s[44:47], s64 offen nt
    s_add_u32 s64, s64, s11
    v_mfma_f32_16x16x32_bf16 v[14:17], v[22:25], v[68:71], v[14:17]
    v_and_b32_dpp v18, v36, v4 row_newbcast:12 row_mask:0xf bank_mask:0xf
    v_and_b32_dpp v19, v36, v5 row_newbcast:12 row_mask:0xf bank_mask:0xf
    v_and_b32_dpp v20, v36, v6 row_newbcast:12 row_mask:0xf bank_mask:0xf
    v_and_b32_dpp v21, v36, v7 row_newbcast:12 row_mask:0xf bank_mask:0xf
    s_waitcnt vmcnt(3)
    buffer_load_dwordx4 v[88:91], v8, s[44:47], s64 offen nt
    s_add_u32 s64, s64, s11
    v_mfma_f32_16x16x32_bf16 v[14:17], v[18:21], v[72:75], v[14:17]
    v_and_b32_dpp v22, v36, v4 row_newbcast:13 row_mask:0xf bank_mask:0xf
    v_and_b32_dpp v23, v36, v5 row_newbcast:13 row_mask:0xf bank_mask:0xf
    v_and_b32_dpp v24, v36, v6 row_newbcast:13 row_mask:0xf bank_mask:0xf
    v_and_b32_dpp v25, v36, v7 row_newbcast:13 row_mask:0xf bank_mask:0xf
    s_waitcnt vmcnt(3)
    buffer_load_dwordx4 v[92:95], v8, s[44:47], s64 offen nt
    s_add_u32 s64, s64, s11
    v_mfma_f32_16x16x32_bf16 v[14:17], v[22:25], v[76:79], v[14:17]
    v_and_b32_dpp v18, v36, v4 row_newbcast:14 row_mask:0xf bank_mask:0xf
    v_and_b32_dpp v19, v36, v5 row_newbcast:14 row_mask:0xf bank_mask:0xf
    v_and_b32_dpp v20, v36, v6 row_newbcast:14 row_mask:0xf bank_mask:0xf
    v_and_b32_dpp v21, v36, v7 row_newbcast:14 row_mask:0xf bank_mask:0xf
    s_waitcnt vmcnt(3)
    buffer_load_dwordx4 v[96:99], v8, s[44:47], s64 offen nt
    s_add_u32 s64, s64, s11
    v_mfma_f32_16x16x32_bf16 v[14:17], v[18:21], v[80:83], v[14:17]
    v_and_b32_dpp v22, v36, v4 row_newbcast:15 row_mask:0xf bank_mask:0xf
    v_and_b32_dpp v23, v36, v5 row_newbcast:15 row_mask:0xf bank_mask:0xf
    v_and_b32_dpp v24, v36, v6 row_newbcast:15 row_mask:0xf bank_mask:0xf
    v_and_b32_dpp v25, v36, v7 row_newbcast:15 row_mask:0xf bank_mask:0xf
    s_waitcnt vmcnt(3)
    buffer_load_dwordx4 v[100:103], v8, s[44:47], s64 offen nt
    s_add_u32 s64, s64, s11
    v_mfma_f32_16x16x32_bf16 v[14:17], v[22:25], v[84:87], v[14:17]
    v_and_b32_dpp v18, v37, v4 row_newbcast:0 row_mask:0xf bank_mask:0xf
    v_and_b32_dpp v19, v37, v5 row_newbcast:0 row_mask:0xf bank_mask:0xf
    v_and_b32_dpp v20, v37, v6 row_newbcast:0 row_mask:0xf bank_mask:0xf
    v_and_b32_dpp v21, v37, v7 row_newbcast:0 row_mask:0xf bank_mask:0xf
    s_waitcnt vmcnt(3)
    buffer_load_dwordx4 v[104:107], v8, s[44:47], s64 offen nt
    s_add_u32 s64, s64, s11
    v_mfma_f32_16x16x32_bf16 v[14:17], v[18:21], v[88:91], v[14:17]
    v_and_b32_dpp v22, v37, v4 row_newbcast:1 row_mask:0xf bank_mask:0xf
    v_and_b32_dpp v23, v37, v5 row_newbcast:1 row_mask:0xf bank_mask:0xf
    v_and_b32_dpp v24, v37, v6 row_newbcast:1 row_mask:0xf bank_mask:0xf
    v_and_b32_dpp v25, v37, v7 row_newbcast:1 row_mask:0xf bank_mask:0xf
    s_waitcnt vmcnt(3)
    buffer_load_dwordx4 v[108:111], v8, s[44:47], s64 offen nt
    s_add_u32 s64, s64, s11
    v_mfma_f32_16x16x32_bf16 v[14:17], v[22:25], v[92:95], v[14:17]
    v_and_b32_dpp v18, v37, v4 row_newbcast:2 row_mask:0xf bank_mask:0xf
    v_and_b32_dpp v19, v37, v5 row_newbcast:2 row_mask:0xf bank_mask:0xf
    v_and_b32_dpp v20, v37, v6 row_newbcast:2 row_mask:0xf bank_mask:0xf
    v_and_b32_dpp v21, v37, v7 row_newbcast:2 row_mask:0xf bank_mask:0xf
    s_waitcnt vmcnt(3)
    buffer_load_dwordx4 v[112:115], v8, s[44:47], s64 offen nt
    s_add_u32 s64, s64, s11
    v_mfma_f32_16x16x32_bf16 v[14:17], v[18:21], v[96:99], v[14:17]
    v_and_b32_dpp v22, v37, v4 row_newbcast:3 row_mask:0xf bank_mask:0xf
    v_and_b32_dpp v23, v37, v5 row_newbcast:3 row_mask:0xf bank_mask:0xf
    v_and_b32_dpp v24, v37, v6 row_newbcast:3 row_mask:0xf bank_mask:0xf
    v_and_b32_dpp v25, v37, v7 row_newbcast:3 row_mask:0xf bank_mask:0xf
    s_waitcnt vmcnt(3)
    buffer_load_dwordx4 v[116:119], v8, s[44:47], s64 offen nt
    s_add_u32 s64, s64, s11
    v_mfma_f32_16x16x32_bf16 v[14:17], v[22:25], v[100:103], v[14:17]
    v_and_b32_dpp v18, v37, v4 row_newbcast:4 row_mask:0xf bank_mask:0xf
    v_and_b32_dpp v19, v37, v5 row_newbcast:4 row_mask:0xf bank_mask:0xf
    v_and_b32_dpp v20, v37, v6 row_newbcast:4 row_mask:0xf bank_mask:0xf
    v_and_b32_dpp v21, v37, v7 row_newbcast:4 row_mask:0xf bank_mask:0xf
    s_waitcnt vmcnt(3)
    buffer_load_dwordx4 v[120:123], v8, s[44:47], s64 offen nt
    s_add_u32 s64, s64, s11
    v_mfma_f32_16x16x32_bf16 v[14:17], v[18:21], v[104:107], v[14:17]
    v_and_b32_dpp v22, v37, v4 row_newbcast:5 row_mask:0xf bank_mask:0xf
    v_and_b32_dpp v23, v37, v5 row_newbcast:5 row_mask:0xf bank_mask:0xf
    v_and_b32_dpp v24, v37, v6 row_newbcast:5 row_mask:0xf bank_mask:0xf
    v_and_b32_dpp v25, v37, v7 row_newbcast:5 row_mask:0xf bank_mask:0xf
    s_waitcnt vmcnt(3)
    buffer_load_dwordx4 v[124:127], v8, s[44:47], s64 offen nt
    s_add_u32 s64, s64, s11
    v_mfma_f32_16x16x32_bf16 v[14:17], v[22:25], v[108:111], v[14:17]
    v_and_b32_dpp v18, v37, v4 row_newbcast:6 row_mask:0xf bank_mask:0xf
    v_and_b32_dpp v19, v37, v5 row_newbcast:6 row_mask:0xf bank_mask:0xf
    v_and_b32_dpp v20, v37, v6 row_newbcast:6 row_mask:0xf bank_mask:0xf
    v_and_b32_dpp v21, v37, v7 row_newbcast:6 row_mask:0xf bank_mask:0xf
    s_waitcnt vmcnt(3)
    buffer_load_dwordx4 v[128:131], v8, s[44:47], s64 offen nt
    s_add_u32 s64, s64, s11
    v_mfma_f32_16x16x32_bf16 v[14:17], v[18:21], v[112:115], v[14:17]
    v_and_b32_dpp v22, v37, v4 row_newbcast:7 row_mask:0xf bank_mask:0xf
    v_and_b32_dpp v23, v37, v5 row_newbcast:7 row_mask:0xf bank_mask:0xf
    v_and_b32_dpp v24, v37, v6 row_newbcast:7 row_mask:0xf bank_mask:0xf
    v_and_b32_dpp v25, v37, v7 row_newbcast:7 row_mask:0xf bank_mask:0xf
    s_waitcnt vmcnt(3)
    buffer_load_dwordx4 v[132:135], v8, s[44:47], s64 offen nt
    s_add_u32 s64, s64, s11
    v_mfma_f32_16x16x32_bf16 v[14:17], v[22:25], v[116:119], v[14:17]
    v_and_b32_dpp v18, v37, v4 row_newbcast:8 row_mask:0xf bank_mask:0xf
    v_and_b32_dpp v19, v37, v5 row_newbcast:8 row_mask:0xf bank_mask:0xf
    v_and_b32_dpp v20, v37, v6 row_newbcast:8 row_mask:0xf bank_mask:0xf
    v_and_b32_dpp v21, v37, v7 row_newbcast:8 row_mask:0xf bank_mask:0xf
    s_waitcnt vmcnt(3)
    buffer_load_dwordx4 v[136:139], v8, s[44:47], s64 offen nt
    s_add_u32 s64, s64, s11
    v_mfma_f32_16x16x32_bf16 v[14:17], v[18:21], v[120:123], v[14:17]
    v_and_b32_dpp v22, v37, v4 row_newbcast:9 row_mask:0xf bank_mask:0xf
    v_and_b32_dpp v23, v37, v5 row_newbcast:9 row_mask:0xf bank_mask:0xf
    v_and_b32_dpp v24, v37, v6 row_newbcast:9 row_mask:0xf bank_mask:0xf
    v_and_b32_dpp v25, v37, v7 row_newbcast:9 row_mask:0xf bank_mask:0xf
    s_waitcnt vmcnt(3)
    buffer_load_dwordx4 v[140:143], v8, s[44:47], s64 offen nt
    s_add_u32 s64, s64, s11
    v_mfma_f32_16x16x32_bf16 v[14:17], v[22:25], v[124:127], v[14:17]
    v_and_b32_dpp v18, v37, v4 row_newbcast:10 row_mask:0xf bank_mask:0xf
    v_and_b32_dpp v19, v37, v5 row_newbcast:10 row_mask:0xf bank_mask:0xf
    v_and_b32_dpp v20, v37, v6 row_newbcast:10 row_mask:0xf bank_mask:0xf
    v_and_b32_dpp v21, v37, v7 row_newbcast:10 row_mask:0xf bank_mask:0xf
    s_waitcnt vmcnt(3)
    buffer_load_dwordx4 v[144:147], v8, s[44:47], s64 offen nt
    s_add_u32 s64, s64, s11
    v_mfma_f32_16x16x32_bf16 v[14:17], v[18:21], v[128:131], v[14:17]
    v_and_b32_dpp v22, v37, v4 row_newbcast:11 row_mask:0xf bank_mask:0xf
    v_and_b32_dpp v23, v37, v5 row_newbcast:11 row_mask:0xf bank_mask:0xf
    v_and_b32_dpp v24, v37, v6 row_newbcast:11 row_mask:0xf bank_mask:0xf
    v_and_b32_dpp v25, v37, v7 row_newbcast:11 row_mask:0xf bank_mask:0xf
    s_waitcnt vmcnt(3)
    buffer_load_dwordx4 v[148:151], v8, s[44:47], s64 offen nt
    s_add_u32 s64, s64, s11
    v_mfma_f32_16x16x32_bf16 v[14:17], v[22:25], v[132:135], v[14:17]
    v_and_b32_dpp v18, v37, v4 row_newbcast:12 row_mask:0xf bank_mask:0xf
    v_and_b32_dpp v19, v37, v5 row_newbcast:12 row_mask:0xf bank_mask:0xf
    v_and_b32_dpp v20, v37, v6 row_newbcast:12 row_mask:0xf bank_mask:0xf
    v_and_b32_dpp v21, v37, v7 row_newbcast:12 row_mask:0xf bank_mask:0xf
    s_waitcnt vmcnt(3)
    buffer_load_dwordx4 v[152:155], v8, s[44:47], s64 offen nt
    s_add_u32 s64, s64, s11
    v_mfma_f32_16x16x32_bf16 v[14:17], v[18:21], v[136:139], v[14:17]
    v_and_b32_dpp v22, v37, v4 row_newbcast:13 row_mask:0xf bank_mask:0xf
    v_and_b32_dpp v23, v37, v5 row_newbcast:13 row_mask:0xf bank_mask:0xf
    v_and_b32_dpp v24, v37, v6 row_newbcast:13 row_mask:0xf bank_mask:0xf
    v_and_b32_dpp v25, v37, v7 row_newbcast:13 row_mask:0xf bank_mask:0xf
    s_waitcnt vmcnt(3)
    buffer_load_dwordx4 v[156:159], v8, s[44:47], s64 offen nt
    s_add_u32 s64, s64, s11
    v_mfma_f32_16x16x32_bf16 v[14:17], v[22:25], v[140:143], v[14:17]
    v_and_b32_dpp v18, v37, v4 row_newbcast:14 row_mask:0xf bank_mask:0xf
    v_and_b32_dpp v19, v37, v5 row_newbcast:14 row_mask:0xf bank_mask:0xf
    v_and_b32_dpp v20, v37, v6 row_newbcast:14 row_mask:0xf bank_mask:0xf
    v_and_b32_dpp v21, v37, v7 row_newbcast:14 row_mask:0xf bank_mask:0xf
    s_waitcnt vmcnt(3)
    buffer_load_dwordx4 v[160:163], v8, s[44:47], s64 offen nt
    s_add_u32 s64, s64, s11
    v_mfma_f32_16x16x32_bf16 v[14:17], v[18:21], v[144:147], v[14:17]
    v_and_b32_dpp v22, v37, v4 row_newbcast:15 row_mask:0xf bank_mask:0xf
    v_and_b32_dpp v23, v37, v5 row_newbcast:15 row_mask:0xf bank_mask:0xf
    v_and_b32_dpp v24, v37, v6 row_newbcast:15 row_mask:0xf bank_mask:0xf
    v_and_b32_dpp v25, v37, v7 row_newbcast:15 row_mask:0xf bank_mask:0xf
    s_waitcnt vmcnt(3)
    buffer_load_dwordx4 v[164:167], v8, s[44:47], s64 offen nt
    s_add_u32 s64, s64, s11
    v_mfma_f32_16x16x32_bf16 v[14:17], v[22:25], v[148:151], v[14:17]
    v_and_b32_dpp v18, v38, v4 row_newbcast:0 row_mask:0xf bank_mask:0xf
    v_and_b32_dpp v19, v38, v5 row_newbcast:0 row_mask:0xf bank_mask:0xf
    v_and_b32_dpp v20, v38, v6 row_newbcast:0 row_mask:0xf bank_mask:0xf
    v_and_b32_dpp v21, v38, v7 row_newbcast:0 row_mask:0xf bank_mask:0xf
    s_waitcnt vmcnt(3)
    buffer_load_dwordx4 v[168:171], v8, s[44:47], s64 offen nt
    s_add_u32 s64, s64, s11
    v_mfma_f32_16x16x32_bf16 v[14:17], v[18:21], v[152:155], v[14:17]
    v_and_b32_dpp v22, v38, v4 row_newbcast:1 row_mask:0xf bank_mask:0xf
    v_and_b32_dpp v23, v38, v5 row_newbcast:1 row_mask:0xf bank_mask:0xf
    v_and_b32_dpp v24, v38, v6 row_newbcast:1 row_mask:0xf bank_mask:0xf
    v_and_b32_dpp v25, v38, v7 row_newbcast:1 row_mask:0xf bank_mask:0xf
    s_waitcnt vmcnt(3)
    buffer_load_dwordx4 v[172:175], v8, s[44:47], s64 offen nt
    s_add_u32 s64, s64, s11
    v_mfma_f32_16x16x32_bf16 v[14:17], v[22:25], v[156:159], v[14:17]
    v_and_b32_dpp v18, v38, v4 row_newbcast:2 row_mask:0xf bank_mask:0xf
    v_and_b32_dpp v19, v38, v5 row_newbcast:2 row_mask:0xf bank_mask:0xf
    v_and_b32_dpp v20, v38, v6 row_newbcast:2 row_mask:0xf bank_mask:0xf
    v_and_b32_dpp v21, v38, v7 row_newbcast:2 row_mask:0xf bank_mask:0xf
    s_waitcnt vmcnt(3)
    buffer_load_dwordx4 v[176:179], v8, s[44:47], s64 offen nt
    s_add_u32 s64, s64, s11
    v_mfma_f32_16x16x32_bf16 v[14:17], v[18:21], v[160:163], v[14:17]
    v_and_b32_dpp v22, v38, v4 row_newbcast:3 row_mask:0xf bank_mask:0xf
    v_and_b32_dpp v23, v38, v5 row_newbcast:3 row_mask:0xf bank_mask:0xf
    v_and_b32_dpp v24, v38, v6 row_newbcast:3 row_mask:0xf bank_mask:0xf
    v_and_b32_dpp v25, v38, v7 row_newbcast:3 row_mask:0xf bank_mask:0xf
    s_waitcnt vmcnt(3)
    buffer_load_dwordx4 v[180:183], v8, s[44:47], s64 offen nt
    s_add_u32 s64, s64, s11
    v_mfma_f32_16x16x32_bf16 v[14:17], v[22:25], v[164:167], v[14:17]
    v_and_b32_dpp v18, v38, v4 row_newbcast:4 row_mask:0xf bank_mask:0xf
    v_and_b32_dpp v19, v38, v5 row_newbcast:4 row_mask:0xf bank_mask:0xf
    v_and_b32_dpp v20, v38, v6 row_newbcast:4 row_mask:0xf bank_mask:0xf
    v_and_b32_dpp v21, v38, v7 row_newbcast:4 row_mask:0xf bank_mask:0xf
    s_waitcnt vmcnt(3)
    buffer_load_dwordx4 v[184:187], v8, s[44:47], s64 offen nt
    s_add_u32 s64, s64, s11
    v_mfma_f32_16x16x32_bf16 v[14:17], v[18:21], v[168:171], v[14:17]
    v_and_b32_dpp v22, v38, v4 row_newbcast:5 row_mask:0xf bank_mask:0xf
    v_and_b32_dpp v23, v38, v5 row_newbcast:5 row_mask:0xf bank_mask:0xf
    v_and_b32_dpp v24, v38, v6 row_newbcast:5 row_mask:0xf bank_mask:0xf
    v_and_b32_dpp v25, v38, v7 row_newbcast:5 row_mask:0xf bank_mask:0xf
    s_waitcnt vmcnt(3)
    buffer_load_dwordx4 v[188:191], v8, s[44:47], s64 offen nt
    s_add_u32 s64, s64, s11
    v_mfma_f32_16x16x32_bf16 v[14:17], v[22:25], v[172:175], v[14:17]
    v_and_b32_dpp v18, v38, v4 row_newbcast:6 row_mask:0xf bank_mask:0xf
    v_and_b32_dpp v19, v38, v5 row_newbcast:6 row_mask:0xf bank_mask:0xf
    v_and_b32_dpp v20, v38, v6 row_newbcast:6 row_mask:0xf bank_mask:0xf
    v_and_b32_dpp v21, v38, v7 row_newbcast:6 row_mask:0xf bank_mask:0xf
    s_waitcnt vmcnt(3)
    buffer_load_dwordx4 v[192:195], v8, s[44:47], s64 offen nt
    s_add_u32 s64, s64, s11
    v_mfma_f32_16x16x32_bf16 v[14:17], v[18:21], v[176:179], v[14:17]
    v_and_b32_dpp v22, v38, v4 row_newbcast:7 row_mask:0xf bank_mask:0xf
    v_and_b32_dpp v23, v38, v5 row_newbcast:7 row_mask:0xf bank_mask:0xf
    v_and_b32_dpp v24, v38, v6 row_newbcast:7 row_mask:0xf bank_mask:0xf
    v_and_b32_dpp v25, v38, v7 row_newbcast:7 row_mask:0xf bank_mask:0xf
    s_waitcnt vmcnt(3)
    buffer_load_dwordx4 v[196:199], v8, s[44:47], s64 offen nt
    s_add_u32 s64, s64, s11
    v_mfma_f32_16x16x32_bf16 v[14:17], v[22:25], v[180:183], v[14:17]
    v_and_b32_dpp v18, v38, v4 row_newbcast:8 row_mask:0xf bank_mask:0xf
    v_and_b32_dpp v19, v38, v5 row_newbcast:8 row_mask:0xf bank_mask:0xf
    v_and_b32_dpp v20, v38, v6 row_newbcast:8 row_mask:0xf bank_mask:0xf
    v_and_b32_dpp v21, v38, v7 row_newbcast:8 row_mask:0xf bank_mask:0xf
    s_waitcnt vmcnt(3)
    buffer_load_dwordx4 v[200:203], v8, s[44:47], s64 offen nt
    s_add_u32 s64, s64, s11
    v_mfma_f32_16x16x32_bf16 v[14:17], v[18:21], v[184:187], v[14:17]
    v_and_b32_dpp v22, v38, v4 row_newbcast:9 row_mask:0xf bank_mask:0xf
    v_and_b32_dpp v23, v38, v5 row_newbcast:9 row_mask:0xf bank_mask:0xf
    v_and_b32_dpp v24, v38, v6 row_newbcast:9 row_mask:0xf bank_mask:0xf
    v_and_b32_dpp v25, v38, v7 row_newbcast:9 row_mask:0xf bank_mask:0xf
    s_waitcnt vmcnt(3)
    buffer_load_dwordx4 v[204:207], v8, s[44:47], s64 offen nt
    s_add_u32 s64, s64, s11
    v_mfma_f32_16x16x32_bf16 v[14:17], v[22:25], v[188:191], v[14:17]
    v_and_b32_dpp v18, v38, v4 row_newbcast:10 row_mask:0xf bank_mask:0xf
    v_and_b32_dpp v19, v38, v5 row_newbcast:10 row_mask:0xf bank_mask:0xf
    v_and_b32_dpp v20, v38, v6 row_newbcast:10 row_mask:0xf bank_mask:0xf
    v_and_b32_dpp v21, v38, v7 row_newbcast:10 row_mask:0xf bank_mask:0xf
    s_waitcnt vmcnt(3)
    buffer_load_dwordx4 v[208:211], v8, s[44:47], s64 offen nt
    s_add_u32 s64, s64, s11
    v_mfma_f32_16x16x32_bf16 v[14:17], v[18:21], v[192:195], v[14:17]
    v_and_b32_dpp v22, v38, v4 row_newbcast:11 row_mask:0xf bank_mask:0xf
    v_and_b32_dpp v23, v38, v5 row_newbcast:11 row_mask:0xf bank_mask:0xf
    v_and_b32_dpp v24, v38, v6 row_newbcast:11 row_mask:0xf bank_mask:0xf
    v_and_b32_dpp v25, v38, v7 row_newbcast:11 row_mask:0xf bank_mask:0xf
    s_waitcnt vmcnt(3)
    buffer_load_dwordx4 v[212:215], v8, s[44:47], s64 offen nt
    s_add_u32 s64, s64, s11
    v_mfma_f32_16x16x32_bf16 v[14:17], v[22:25], v[196:199], v[14:17]
    v_and_b32_dpp v18, v38, v4 row_newbcast:12 row_mask:0xf bank_mask:0xf
    v_and_b32_dpp v19, v38, v5 row_newbcast:12 row_mask:0xf bank_mask:0xf
    v_and_b32_dpp v20, v38, v6 row_newbcast:12 row_mask:0xf bank_mask:0xf
    v_and_b32_dpp v21, v38, v7 row_newbcast:12 row_mask:0xf bank_mask:0xf
    s_waitcnt vmcnt(3)
    buffer_load_dwordx4 v[216:219], v8, s[44:47], s64 offen nt
    s_add_u32 s64, s64, s11
    v_mfma_f32_16x16x32_bf16 v[14:17], v[18:21], v[200:203], v[14:17]
    v_and_b32_dpp v22, v38, v4 row_newbcast:13 row_mask:0xf bank_mask:0xf
    v_and_b32_dpp v23, v38, v5 row_newbcast:13 row_mask:0xf bank_mask:0xf
    v_and_b32_dpp v24, v38, v6 row_newbcast:13 row_mask:0xf bank_mask:0xf
    v_and_b32_dpp v25, v38, v7 row_newbcast:13 row_mask:0xf bank_mask:0xf
    s_waitcnt vmcnt(3)
    buffer_load_dwordx4 v[220:223], v8, s[44:47], s64 offen nt
    s_add_u32 s64, s64, s11
    v_mfma_f32_16x16x32_bf16 v[14:17], v[22:25], v[204:207], v[14:17]
    v_and_b32_dpp v18, v38, v4 row_newbcast:14 row_mask:0xf bank_mask:0xf
    v_and_b32_dpp v19, v38, v5 row_newbcast:14 row_mask:0xf bank_mask:0xf
    v_and_b32_dpp v20, v38, v6 row_newbcast:14 row_mask:0xf bank_mask:0xf
    v_and_b32_dpp v21, v38, v7 row_newbcast:14 row_mask:0xf bank_mask:0xf
    s_waitcnt vmcnt(3)
    buffer_load_dwordx4 v[224:227], v8, s[44:47], s64 offen nt
    s_add_u32 s64, s64, s11
    v_mfma_f32_16x16x32_bf16 v[14:17], v[18:21], v[208:211], v[14:17]
    v_and_b32_dpp v22, v38, v4 row_newbcast:15 row_mask:0xf bank_mask:0xf
    v_and_b32_dpp v23, v38, v5 row_newbcast:15 row_mask:0xf bank_mask:0xf
    v_and_b32_dpp v24, v38, v6 row_newbcast:15 row_mask:0xf bank_mask:0xf
    v_and_b32_dpp v25, v38, v7 row_newbcast:15 row_mask:0xf bank_mask:0xf
    s_waitcnt vmcnt(3)
    buffer_load_dwordx4 v[228:231], v8, s[44:47], s64 offen nt
    s_add_u32 s64, s64, s11
    v_mfma_f32_16x16x32_bf16 v[14:17], v[22:25], v[212:215], v[14:17]
    v_and_b32_dpp v18, v39, v4 row_newbcast:0 row_mask:0xf bank_mask:0xf
    v_and_b32_dpp v19, v39, v5 row_newbcast:0 row_mask:0xf bank_mask:0xf
    v_and_b32_dpp v20, v39, v6 row_newbcast:0 row_mask:0xf bank_mask:0xf
    v_and_b32_dpp v21, v39, v7 row_newbcast:0 row_mask:0xf bank_mask:0xf
    s_waitcnt vmcnt(3)
    buffer_load_dwordx4 v[232:235], v8, s[44:47], s64 offen nt
    s_add_u32 s64, s64, s11
    v_mfma_f32_16x16x32_bf16 v[14:17], v[18:21], v[216:219], v[14:17]
    v_and_b32_dpp v22, v39, v4 row_newbcast:1 row_mask:0xf bank_mask:0xf
    v_and_b32_dpp v23, v39, v5 row_newbcast:1 row_mask:0xf bank_mask:0xf
    v_and_b32_dpp v24, v39, v6 row_newbcast:1 row_mask:0xf bank_mask:0xf
    v_and_b32_dpp v25, v39, v7 row_newbcast:1 row_mask:0xf bank_mask:0xf
    s_waitcnt vmcnt(3)
    buffer_load_dwordx4 v[236:239], v8, s[44:47], s64 offen nt
    s_add_u32 s64, s64, s11
    v_mfma_f32_16x16x32_bf16 v[14:17], v[22:25], v[220:223], v[14:17]
    v_and_b32_dpp v18, v39, v4 row_newbcast:2 row_mask:0xf bank_mask:0xf
    v_and_b32_dpp v19, v39, v5 row_newbcast:2 row_mask:0xf bank_mask:0xf
    v_and_b32_dpp v20, v39, v6 row_newbcast:2 row_mask:0xf bank_mask:0xf
    v_and_b32_dpp v21, v39, v7 row_newbcast:2 row_mask:0xf bank_mask:0xf
    s_waitcnt vmcnt(3)
    buffer_load_dwordx4 v[240:243], v8, s[44:47], s64 offen nt
    s_add_u32 s64, s64, s11
    v_mfma_f32_16x16x32_bf16 v[14:17], v[18:21], v[224:227], v[14:17]
    v_and_b32_dpp v22, v39, v4 row_newbcast:3 row_mask:0xf bank_mask:0xf
    v_and_b32_dpp v23, v39, v5 row_newbcast:3 row_mask:0xf bank_mask:0xf
    v_and_b32_dpp v24, v39, v6 row_newbcast:3 row_mask:0xf bank_mask:0xf
    v_and_b32_dpp v25, v39, v7 row_newbcast:3 row_mask:0xf bank_mask:0xf
    s_waitcnt vmcnt(3)
    buffer_load_dwordx4 v[244:247], v8, s[44:47], s64 offen nt
    s_add_u32 s64, s64, s11
    v_mfma_f32_16x16x32_bf16 v[14:17], v[22:25], v[228:231], v[14:17]
    v_and_b32_dpp v18, v39, v4 row_newbcast:4 row_mask:0xf bank_mask:0xf
    v_and_b32_dpp v19, v39, v5 row_newbcast:4 row_mask:0xf bank_mask:0xf
    v_and_b32_dpp v20, v39, v6 row_newbcast:4 row_mask:0xf bank_mask:0xf
    v_and_b32_dpp v21, v39, v7 row_newbcast:4 row_mask:0xf bank_mask:0xf
    s_waitcnt vmcnt(3)
    buffer_load_dwordx4 v[248:251], v8, s[44:47], s64 offen nt
    s_add_u32 s64, s64, s11
    v_mfma_f32_16x16x32_bf16 v[14:17], v[18:21], v[232:235], v[14:17]
    v_and_b32_dpp v22, v39, v4 row_newbcast:5 row_mask:0xf bank_mask:0xf
    v_and_b32_dpp v23, v39, v5 row_newbcast:5 row_mask:0xf bank_mask:0xf
    v_and_b32_dpp v24, v39, v6 row_newbcast:5 row_mask:0xf bank_mask:0xf
    v_and_b32_dpp v25, v39, v7 row_newbcast:5 row_mask:0xf bank_mask:0xf
    s_waitcnt vmcnt(3)
    buffer_load_dwordx4 v[252:255], v8, s[44:47], s64 offen nt
    s_add_u32 s64, s64, s11
    v_mfma_f32_16x16x32_bf16 v[14:17], v[22:25], v[236:239], v[14:17]
    v_and_b32_dpp v18, v39, v4 row_newbcast:6 row_mask:0xf bank_mask:0xf
    v_and_b32_dpp v19, v39, v5 row_newbcast:6 row_mask:0xf bank_mask:0xf
    v_and_b32_dpp v20, v39, v6 row_newbcast:6 row_mask:0xf bank_mask:0xf
    v_and_b32_dpp v21, v39, v7 row_newbcast:6 row_mask:0xf bank_mask:0xf
    s_waitcnt vmcnt(3)
    buffer_load_dwordx4 v[64:67], v8, s[44:47], s64 offen nt
    s_add_u32 s64, s64, s11
    v_mfma_f32_16x16x32_bf16 v[14:17], v[18:21], v[240:243], v[14:17]
    v_and_b32_dpp v22, v39, v4 row_newbcast:7 row_mask:0xf bank_mask:0xf
    v_and_b32_dpp v23, v39, v5 row_newbcast:7 row_mask:0xf bank_mask:0xf
    v_and_b32_dpp v24, v39, v6 row_newbcast:7 row_mask:0xf bank_mask:0xf
    v_and_b32_dpp v25, v39, v7 row_newbcast:7 row_mask:0xf bank_mask:0xf
    s_waitcnt vmcnt(3)
    buffer_load_dwordx4 v[68:71], v8, s[44:47], s64 offen nt
    s_add_u32 s64, s64, s11
    v_mfma_f32_16x16x32_bf16 v[14:17], v[22:25], v[244:247], v[14:17]
    v_and_b32_dpp v18, v39, v4 row_newbcast:8 row_mask:0xf bank_mask:0xf
    v_and_b32_dpp v19, v39, v5 row_newbcast:8 row_mask:0xf bank_mask:0xf
    v_and_b32_dpp v20, v39, v6 row_newbcast:8 row_mask:0xf bank_mask:0xf
    v_and_b32_dpp v21, v39, v7 row_newbcast:8 row_mask:0xf bank_mask:0xf
    s_waitcnt vmcnt(3)
    buffer_load_dwordx4 v[72:75], v8, s[44:47], s64 offen nt
    s_add_u32 s64, s64, s11
    v_mfma_f32_16x16x32_bf16 v[14:17], v[18:21], v[248:251], v[14:17]
    v_and_b32_dpp v22, v39, v4 row_newbcast:9 row_mask:0xf bank_mask:0xf
    v_and_b32_dpp v23, v39, v5 row_newbcast:9 row_mask:0xf bank_mask:0xf
    v_and_b32_dpp v24, v39, v6 row_newbcast:9 row_mask:0xf bank_mask:0xf
    v_and_b32_dpp v25, v39, v7 row_newbcast:9 row_mask:0xf bank_mask:0xf
    s_waitcnt vmcnt(3)
    buffer_load_dwordx4 v[76:79], v8, s[44:47], s64 offen nt
    s_add_u32 s64, s64, s11
    v_mfma_f32_16x16x32_bf16 v[14:17], v[22:25], v[252:255], v[14:17]
    v_and_b32_dpp v18, v39, v4 row_newbcast:10 row_mask:0xf bank_mask:0xf
    v_and_b32_dpp v19, v39, v5 row_newbcast:10 row_mask:0xf bank_mask:0xf
    v_and_b32_dpp v20, v39, v6 row_newbcast:10 row_mask:0xf bank_mask:0xf
    v_and_b32_dpp v21, v39, v7 row_newbcast:10 row_mask:0xf bank_mask:0xf
    s_waitcnt vmcnt(3)
    buffer_load_dwordx4 v[80:83], v8, s[44:47], s64 offen nt
    s_add_u32 s64, s64, s11
    v_mfma_f32_16x16x32_bf16 v[14:17], v[18:21], v[64:67], v[14:17]
    v_and_b32_dpp v22, v39, v4 row_newbcast:11 row_mask:0xf bank_mask:0xf
    v_and_b32_dpp v23, v39, v5 row_newbcast:11 row_mask:0xf bank_mask:0xf
    v_and_b32_dpp v24, v39, v6 row_newbcast:11 row_mask:0xf bank_mask:0xf
    v_and_b32_dpp v25, v39, v7 row_newbcast:11 row_mask:0xf bank_mask:0xf
    s_waitcnt vmcnt(3)
    buffer_load_dwordx4 v[84:87], v8, s[44:47], s64 offen nt
    s_add_u32 s64, s64, s11
    v_mfma_f32_16x16x32_bf16 v[14:17], v[22:25], v[68:71], v[14:17]
    v_and_b32_dpp v18, v39, v4 row_newbcast:12 row_mask:0xf bank_mask:0xf
    v_and_b32_dpp v19, v39, v5 row_newbcast:12 row_mask:0xf bank_mask:0xf
    v_and_b32_dpp v20, v39, v6 row_newbcast:12 row_mask:0xf bank_mask:0xf
    v_and_b32_dpp v21, v39, v7 row_newbcast:12 row_mask:0xf bank_mask:0xf
    s_waitcnt vmcnt(3)
    buffer_load_dwordx4 v[88:91], v8, s[44:47], s64 offen nt
    s_add_u32 s64, s64, s11
    v_mfma_f32_16x16x32_bf16 v[14:17], v[18:21], v[72:75], v[14:17]
    v_and_b32_dpp v22, v39, v4 row_newbcast:13 row_mask:0xf bank_mask:0xf
    v_and_b32_dpp v23, v39, v5 row_newbcast:13 row_mask:0xf bank_mask:0xf
    v_and_b32_dpp v24, v39, v6 row_newbcast:13 row_mask:0xf bank_mask:0xf
    v_and_b32_dpp v25, v39, v7 row_newbcast:13 row_mask:0xf bank_mask:0xf
    s_waitcnt vmcnt(3)
    buffer_load_dwordx4 v[92:95], v8, s[44:47], s64 offen nt
    s_add_u32 s64, s64, s11
    v_mfma_f32_16x16x32_bf16 v[14:17], v[22:25], v[76:79], v[14:17]
    v_and_b32_dpp v18, v39, v4 row_newbcast:14 row_mask:0xf bank_mask:0xf
    v_and_b32_dpp v19, v39, v5 row_newbcast:14 row_mask:0xf bank_mask:0xf
    v_and_b32_dpp v20, v39, v6 row_newbcast:14 row_mask:0xf bank_mask:0xf
    v_and_b32_dpp v21, v39, v7 row_newbcast:14 row_mask:0xf bank_mask:0xf
    s_waitcnt vmcnt(3)
    buffer_load_dwordx4 v[96:99], v8, s[44:47], s64 offen nt
    s_add_u32 s64, s64, s11
    v_mfma_f32_16x16x32_bf16 v[14:17], v[18:21], v[80:83], v[14:17]
    v_and_b32_dpp v22, v39, v4 row_newbcast:15 row_mask:0xf bank_mask:0xf
    v_and_b32_dpp v23, v39, v5 row_newbcast:15 row_mask:0xf bank_mask:0xf
    v_and_b32_dpp v24, v39, v6 row_newbcast:15 row_mask:0xf bank_mask:0xf
    v_and_b32_dpp v25, v39, v7 row_newbcast:15 row_mask:0xf bank_mask:0xf
    s_waitcnt vmcnt(3)
    buffer_load_dwordx4 v[100:103], v8, s[44:47], s64 offen nt
    s_add_u32 s64, s64, s11
    v_mfma_f32_16x16x32_bf16 v[14:17], v[22:25], v[84:87], v[14:17]
    v_and_b32_dpp v18, v40, v4 row_newbcast:0 row_mask:0xf bank_mask:0xf
    v_and_b32_dpp v19, v40, v5 row_newbcast:0 row_mask:0xf bank_mask:0xf
    v_and_b32_dpp v20, v40, v6 row_newbcast:0 row_mask:0xf bank_mask:0xf
    v_and_b32_dpp v21, v40, v7 row_newbcast:0 row_mask:0xf bank_mask:0xf
    s_waitcnt vmcnt(3)
    buffer_load_dwordx4 v[104:107], v8, s[44:47], s64 offen nt
    s_add_u32 s64, s64, s11
    v_mfma_f32_16x16x32_bf16 v[14:17], v[18:21], v[88:91], v[14:17]
    v_and_b32_dpp v22, v40, v4 row_newbcast:1 row_mask:0xf bank_mask:0xf
    v_and_b32_dpp v23, v40, v5 row_newbcast:1 row_mask:0xf bank_mask:0xf
    v_and_b32_dpp v24, v40, v6 row_newbcast:1 row_mask:0xf bank_mask:0xf
    v_and_b32_dpp v25, v40, v7 row_newbcast:1 row_mask:0xf bank_mask:0xf
    s_waitcnt vmcnt(3)
    buffer_load_dwordx4 v[108:111], v8, s[44:47], s64 offen nt
    s_add_u32 s64, s64, s11
    v_mfma_f32_16x16x32_bf16 v[14:17], v[22:25], v[92:95], v[14:17]
    v_and_b32_dpp v18, v40, v4 row_newbcast:2 row_mask:0xf bank_mask:0xf
    v_and_b32_dpp v19, v40, v5 row_newbcast:2 row_mask:0xf bank_mask:0xf
    v_and_b32_dpp v20, v40, v6 row_newbcast:2 row_mask:0xf bank_mask:0xf
    v_and_b32_dpp v21, v40, v7 row_newbcast:2 row_mask:0xf bank_mask:0xf
    s_waitcnt vmcnt(3)
    buffer_load_dwordx4 v[112:115], v8, s[44:47], s64 offen nt
    s_add_u32 s64, s64, s11
    v_mfma_f32_16x16x32_bf16 v[14:17], v[18:21], v[96:99], v[14:17]
    v_and_b32_dpp v22, v40, v4 row_newbcast:3 row_mask:0xf bank_mask:0xf
    v_and_b32_dpp v23, v40, v5 row_newbcast:3 row_mask:0xf bank_mask:0xf
    v_and_b32_dpp v24, v40, v6 row_newbcast:3 row_mask:0xf bank_mask:0xf
    v_and_b32_dpp v25, v40, v7 row_newbcast:3 row_mask:0xf bank_mask:0xf
    s_waitcnt vmcnt(3)
    buffer_load_dwordx4 v[116:119], v8, s[44:47], s64 offen nt
    s_add_u32 s64, s64, s11
    v_mfma_f32_16x16x32_bf16 v[14:17], v[22:25], v[100:103], v[14:17]
    v_and_b32_dpp v18, v40, v4 row_newbcast:4 row_mask:0xf bank_mask:0xf
    v_and_b32_dpp v19, v40, v5 row_newbcast:4 row_mask:0xf bank_mask:0xf
    v_and_b32_dpp v20, v40, v6 row_newbcast:4 row_mask:0xf bank_mask:0xf
    v_and_b32_dpp v21, v40, v7 row_newbcast:4 row_mask:0xf bank_mask:0xf
    s_waitcnt vmcnt(3)
    buffer_load_dwordx4 v[120:123], v8, s[44:47], s64 offen nt
    s_add_u32 s64, s64, s11
    v_mfma_f32_16x16x32_bf16 v[14:17], v[18:21], v[104:107], v[14:17]
    v_and_b32_dpp v22, v40, v4 row_newbcast:5 row_mask:0xf bank_mask:0xf
    v_and_b32_dpp v23, v40, v5 row_newbcast:5 row_mask:0xf bank_mask:0xf
    v_and_b32_dpp v24, v40, v6 row_newbcast:5 row_mask:0xf bank_mask:0xf
    v_and_b32_dpp v25, v40, v7 row_newbcast:5 row_mask:0xf bank_mask:0xf
    s_waitcnt vmcnt(3)
    buffer_load_dwordx4 v[124:127], v8, s[44:47], s64 offen nt
    s_add_u32 s64, s64, s11
    v_mfma_f32_16x16x32_bf16 v[14:17], v[22:25], v[108:111], v[14:17]
    v_and_b32_dpp v18, v40, v4 row_newbcast:6 row_mask:0xf bank_mask:0xf
    v_and_b32_dpp v19, v40, v5 row_newbcast:6 row_mask:0xf bank_mask:0xf
    v_and_b32_dpp v20, v40, v6 row_newbcast:6 row_mask:0xf bank_mask:0xf
    v_and_b32_dpp v21, v40, v7 row_newbcast:6 row_mask:0xf bank_mask:0xf
    s_mov_b32 s82, 400000
L_side:
    ds_read_b64 v[44:45], v35 offset:256
    s_sub_u32 s82, s82, 1
    s_cmp_eq_u32 s82, 0
    s_cselect_b64 s[76:77], 0, -1
    s_waitcnt lgkmcnt(0)
    v_cmp_eq_u32 vcc, -1, v45
    s_nop 0
    s_and_b64 vcc, vcc, s[76:77]
    s_cbranch_vccnz L_side
    v_mov_b32 v46, v44
    s_nop 1
    v_max_f32_dpp v46, v46, v46 quad_perm:[1,0,3,2] row_mask:0xf bank_mask:0xf
    s_nop 1
    v_max_f32_dpp v46, v46, v46 quad_perm:[2,3,0,1] row_mask:0xf bank_mask:0xf
    s_nop 1
    v_max_f32_dpp v46, v46, v46 row_half_mirror row_mask:0xf bank_mask:0xf
    v_sub_f32 v34, v26, v46
    v_sub_f32 v44, v44, v46
    v_mul_f32 v34, s69, v34
    v_mul_f32 v44, s69, v44
    v_exp_f32 v34, v34
    v_exp_f32 v44, v44
    s_nop 0
    v_mul_f32 v48, v44, v45
    v_mov_b32 v47, s12
    v_mov_b32 v49, s12
    v_add_f32_dpp v48, v48, v48 quad_perm:[1,0,3,2] row_mask:0xf bank_mask:0xf
    s_nop 1
    v_add_f32_dpp v48, v48, v48 quad_perm:[2,3,0,1] row_mask:0xf bank_mask:0xf
    s_nop 1
    v_add_f32_dpp v48, v48, v48 row_half_mirror row_mask:0xf bank_mask:0xf
    s_cmp_lg_u32 s3, 0
    s_cbranch_scc1 L_side_x
    s_mov_b64 exec, 1
    buffer_store_dwordx4 v[46:49], v29, s[40:43], s67 offen sc1
    s_mov_b64 exec, -1
L_side_x:
    s_waitcnt vmcnt(3)
    buffer_load_dwordx4 v[128:131], v8, s[44:47], s64 offen nt
    s_add_u32 s64, s64, s11
    v_mfma_f32_16x16x32_bf16 v[14:17], v[18:21], v[112:115], v[14:17]
    v_and_b32_dpp v22, v40, v4 row_newbcast:7 row_mask:0xf bank_mask:0xf
    v_and_b32_dpp v23, v40, v5 row_newbcast:7 row_mask:0xf bank_mask:0xf
    v_and_b32_dpp v24, v40, v6 row_newbcast:7 row_mask:0xf bank_mask:0xf
    v_and_b32_dpp v25, v40, v7 row_newbcast:7 row_mask:0xf bank_mask:0xf
    s_waitcnt vmcnt(3)
    buffer_load_dwordx4 v[132:135], v8, s[44:47], s64 offen nt
    s_add_u32 s64, s64, s11
    v_mfma_f32_16x16x32_bf16 v[14:17], v[22:25], v[116:119], v[14:17]
    v_and_b32_dpp v18, v40, v4 row_newbcast:8 row_mask:0xf bank_mask:0xf
    v_and_b32_dpp v19, v40, v5 row_newbcast:8 row_mask:0xf bank_mask:0xf
    v_and_b32_dpp v20, v40, v6 row_newbcast:8 row_mask:0xf bank_mask:0xf
    v_and_b32_dpp v21, v40, v7 row_newbcast:8 row_mask:0xf bank_mask:0xf
    s_waitcnt vmcnt(3)
    buffer_load_dwordx4 v[136:139], v8, s[44:47], s64 offen nt
    s_add_u32 s64, s64, s11
    v_mfma_f32_16x16x32_bf16 v[14:17], v[18:21], v[120:123], v[14:17]
    v_and_b32_dpp v22, v40, v4 row_newbcast:9 row_mask:0xf bank_mask:0xf
    v_and_b32_dpp v23, v40, v5 row_newbcast:9 row_mask:0xf bank_mask:0xf
    v_and_b32_dpp v24, v40, v6 row_newbcast:9 row_mask:0xf bank_mask:0xf
    v_and_b32_dpp v25, v40, v7 row_newbcast:9 row_mask:0xf bank_mask:0xf
    s_waitcnt vmcnt(3)
    buffer_load_dwordx4 v[140:143], v8, s[44:47], s64 offen nt
    s_add_u32 s64, s64, s11
    v_mfma_f32_16x16x32_bf16 v[14:17], v[22:25], v[124:127], v[14:17]
    v_and_b32_dpp v18, v40, v4 row_newbcast:10 row_mask:0xf bank_mask:0xf
    v_and_b32_dpp v19, v40, v5 row_newbcast:10 row_mask:0xf bank_mask:0xf
    v_and_b32_dpp v20, v40, v6 row_newbcast:10 row_mask:0xf bank_mask:0xf
    v_and_b32_dpp v21, v40, v7 row_newbcast:10 row_mask:0xf bank_mask:0xf
    s_waitcnt vmcnt(3)
    buffer_load_dwordx4 v[144:147], v8, s[44:47], s64 offen nt
    s_add_u32 s64, s64, s11
    v_mfma_f32_16x16x32_bf16 v[14:17], v[18:21], v[128:131], v[14:17]
    v_and_b32_dpp v22, v40, v4 row_newbcast:11 row_mask:0xf bank_mask:0xf
    v_and_b32_dpp v23, v40, v5 row_newbcast:11 row_mask:0xf bank_mask:0xf
    v_and_b32_dpp v24, v40, v6 row_newbcast:11 row_mask:0xf bank_mask:0xf
    v_and_b32_dpp v25, v40, v7 row_newbcast:11 row_mask:0xf bank_mask:0xf
    s_waitcnt vmcnt(3)
    buffer_load_dwordx4 v[148:151], v8, s[44:47], s64 offen nt
    s_add_u32 s64, s64, s11
    v_mfma_f32_16x16x32_bf16 v[14:17], v[22:25], v[132:135], v[14:17]
    v_and_b32_dpp v18, v40, v4 row_newbcast:12 row_mask:0xf bank_mask:0xf
    v_and_b32_dpp v19, v40, v5 row_newbcast:12 row_mask:0xf bank_mask:0xf
    v_and_b32_dpp v20, v40, v6 row_newbcast:12 row_mask:0xf bank_mask:0xf
    v_and_b32_dpp v21, v40, v7 row_newbcast:12 row_mask:0xf bank_mask:0xf
    s_waitcnt vmcnt(3)
    buffer_load_dwordx4 v[152:155], v8, s[44:47], s64 offen nt
    s_add_u32 s64, s64, s11
    v_mfma_f32_16x16x32_bf16 v[14:17], v[18:21], v[136:139], v[14:17]
    v_and_b32_dpp v22, v40, v4 row_newbcast:13 row_mask:0xf bank_mask:0xf
    v_and_b32_dpp v23, v40, v5 row_newbcast:13 row_mask:0xf bank_mask:0xf
    v_and_b32_dpp v24, v40, v6 row_newbcast:13 row_mask:0xf bank_mask:0xf
    v_and_b32_dpp v25, v40, v7 row_newbcast:13 row_mask:0xf bank_mask:0xf
    s_waitcnt vmcnt(3)
    buffer_load_dwordx4 v[156:159], v8, s[44:47], s64 offen nt
    s_add_u32 s64, s64, s11
    v_mfma_f32_16x16x32_bf16 v[14:17], v[22:25], v[140:143], v[14:17]
    v_and_b32_dpp v18, v40, v4 row_newbcast:14 row_mask:0xf bank_mask:0xf
    v_and_b32_dpp v19, v40, v5 row_newbcast:14 row_mask:0xf bank_mask:0xf
    v_and_b32_dpp v20, v40, v6 row_newbcast:14 row_mask:0xf bank_mask:0xf
    v_and_b32_dpp v21, v40, v7 row_newbcast:14 row_mask:0xf bank_mask:0xf
    s_waitcnt vmcnt(3)
    buffer_load_dwordx4 v[160:163], v8, s[44:47], s64 offen nt
    s_add_u32 s64, s64, s11
    v_mfma_f32_16x16x32_bf16 v[14:17], v[18:21], v[144:147], v[14:17]
    v_and_b32_dpp v22, v40, v4 row_newbcast:15 row_mask:0xf bank_mask:0xf
    v_and_b32_dpp v23, v40, v5 row_newbcast:15 row_mask:0xf bank_mask:0xf
    v_and_b32_dpp v24, v40, v6 row_newbcast:15 row_mask:0xf bank_mask:0xf
    v_and_b32_dpp v25, v40, v7 row_newbcast:15 row_mask:0xf bank_mask:0xf
    s_waitcnt vmcnt(3)
    buffer_load_dwordx4 v[164:167], v8, s[44:47], s64 offen nt
    s_add_u32 s64, s64, s11
    v_mfma_f32_16x16x32_bf16 v[14:17], v[22:25], v[148:151], v[14:17]
    v_and_b32_dpp v18, v41, v4 row_newbcast:0 row_mask:0xf bank_mask:0xf
    v_and_b32_dpp v19, v41, v5 row_newbcast:0 row_mask:0xf bank_mask:0xf
    v_and_b32_dpp v20, v41, v6 row_newbcast:0 row_mask:0xf bank_mask:0xf
    v_and_b32_dpp v21, v41, v7 row_newbcast:0 row_mask:0xf bank_mask:0xf
    s_waitcnt vmcnt(3)
    buffer_load_dwordx4 v[168:171], v8, s[44:47], s64 offen nt
    s_add_u32 s64, s64, s11
    v_mfma_f32_16x16x32_bf16 v[14:17], v[18:21], v[152:155], v[14:17]
    v_and_b32_dpp v22, v41, v4 row_newbcast:1 row_mask:0xf bank_mask:0xf
    v_and_b32_dpp v23, v41, v5 row_newbcast:1 row_mask:0xf bank_mask:0xf
    v_and_b32_dpp v24, v41, v6 row_newbcast:1 row_mask:0xf bank_mask:0xf
    v_and_b32_dpp v25, v41, v7 row_newbcast:1 row_mask:0xf bank_mask:0xf
    s_waitcnt vmcnt(3)
    buffer_load_dwordx4 v[172:175], v8, s[44:47], s64 offen nt
    s_add_u32 s64, s64, s11
    v_mfma_f32_16x16x32_bf16 v[14:17], v[22:25], v[156:159], v[14:17]
    v_and_b32_dpp v18, v41, v4 row_newbcast:2 row_mask:0xf bank_mask:0xf
    v_and_b32_dpp v19, v41, v5 row_newbcast:2 row_mask:0xf bank_mask:0xf
    v_and_b32_dpp v20, v41, v6 row_newbcast:2 row_mask:0xf bank_mask:0xf
    v_and_b32_dpp v21, v41, v7 row_newbcast:2 row_mask:0xf bank_mask:0xf
    s_waitcnt vmcnt(3)
    s_nop 0
    v_mfma_f32_16x16x32_bf16 v[14:17], v[18:21], v[160:163], v[14:17]
    v_and_b32_dpp v22, v41, v4 row_newbcast:3 row_mask:0xf bank_mask:0xf
    v_and_b32_dpp v23, v41, v5 row_newbcast:3 row_mask:0xf bank_mask:0xf
    v_and_b32_dpp v24, v41, v6 row_newbcast:3 row_mask:0xf bank_mask:0xf
    v_and_b32_dpp v25, v41, v7 row_newbcast:3 row_mask:0xf bank_mask:0xf
    s_waitcnt vmcnt(2)
    s_nop 0
    v_mfma_f32_16x16x32_bf16 v[14:17], v[22:25], v[164:167], v[14:17]
    v_and_b32_dpp v18, v41, v4 row_newbcast:4 row_mask:0xf bank_mask:0xf
    v_and_b32_dpp v19, v41, v5 row_newbcast:4 row_mask:0xf bank_mask:0xf
    v_and_b32_dpp v20, v41, v6 row_newbcast:4 row_mask:0xf bank_mask:0xf
    v_and_b32_dpp v21, v41, v7 row_newbcast:4 row_mask:0xf bank_mask:0xf
    s_waitcnt vmcnt(1)
    s_nop 0
    v_mfma_f32_16x16x32_bf16 v[14:17], v[18:21], v[168:171], v[14:17]
    v_and_b32_dpp v22, v41, v4 row_newbcast:5 row_mask:0xf bank_mask:0xf
    v_and_b32_dpp v23, v41, v5 row_newbcast:5 row_mask:0xf bank_mask:0xf
    v_and_b32_dpp v24, v41, v6 row_newbcast:5 row_mask:0xf bank_mask:0xf
    v_and_b32_dpp v25, v41, v7 row_newbcast:5 row_mask:0xf bank_mask:0xf
    s_waitcnt vmcnt(0)
    s_nop 0
    v_mfma_f32_16x16x32_bf16 v[14:17], v[22:25], v[172:175], v[14:17]
    s_nop 7
    v_pk_mul_f32 v[14:15], v[14:15], v[34:35] op_sel_hi:[1,0]
    v_pk_mul_f32 v[16:17], v[16:17], v[34:35] op_sel_hi:[1,0]
    s_mov_b64 exec, 0xffffffff
    ds_write_b128 v28, v[14:17] offset:16384
    s_mov_b64 exec, 1
    ds_add_rtn_u32 v31, v29, v31 offset:320
    s_mov_b64 exec, -1
    ds_read_b128 v[44:47], v30 offset:16384
    ds_read_b128 v[48:51], v30 offset:17408
    ds_read_b128 v[52:55], v30 offset:18432
    ds_read_b128 v[56:59], v30 offset:19456
    v_and_b32 v18, 0x1ff, v30
    v_lshrrev_b32 v19, 5, v1
    v_lshl_add_u32 v18, v19, 3, v18
    s_waitcnt lgkmcnt(4)
    v_readfirstlane_b32 s68, v31
    s_nop 0
    s_cmp_lg_u32 s68, 7
    s_cbranch_scc1 L_stail
    s_waitcnt lgkmcnt(2)
    v_pk_add_f32 v[44:45], v[44:45], v[48:49]
    v_pk_add_f32 v[46:47], v[46:47], v[50:51]
    s_waitcnt lgkmcnt(0)
    v_pk_add_f32 v[52:53], v[52:53], v[56:57]
    v_pk_add_f32 v[54:55], v[54:55], v[58:59]
    v_pk_add_f32 v[44:45], v[44:45], v[52:53]
    v_pk_add_f32 v[46:47], v[46:47], v[54:55]
    s_nop 1
    v_permlane32_swap_b32 v44, v46
    v_permlane32_swap_b32 v45, v47
    v_pk_add_f32 v[44:45], v[44:45], v[46:47]
    v_bfi_b32 v44, v63, s12, v44
    v_bfi_b32 v45, v63, s12, v45
    buffer_store_dwordx2 v[44:45], v18, s[40:43], s66 offen sc1
L_stail:
    s_waitcnt lgkmcnt(0)
    s_cmp_ge_u32 s15, 40
    s_cbranch_scc1 L_exit
    s_lshl_b32 s67, s15, 5
    s_lshl_b32 s66, s3, 2
    s_add_u32 s67, s67, s66
    v_and_b32 v28, 1, v2
    v_and_b32 v29, 2, v2
    v_mul_u32_u24 v8, 1280, v28
    v_add_u32 v8, v8, v29
    buffer_load_ushort v24, v8, s[56:59], s67 offen
    s_lshl_b32 s66, s15, 7
    s_lshl_b32 s68, s3, 3
    s_add_u32 s64, s66, s68
    s_add_u32 s65, s64, s68
    s_add_u32 s64, s64, 102400
    s_add_u32 s65, s65, 143360
    v_and_b32 v9, 3, v1
    v_mul_u32_u24 v9, 5120, v9
    v_lshl_add_u32 v9, v28, 6, v9
    v_lshl_add_u32 v9, v29, 1, v9
    v_mul_u32_u24 v10, 5120, v1
    v_cmp_gt_u32 s[72:73], 27, v1
    v_cmp_eq_u32 s[74:75], 0, v3
    v_mov_b32 v20, 0
    v_mov_b32 v21, 0
    v_mov_b32 v22, 0
    v_mov_b32 v23, 0
    s_mov_b32 s82, 400000
    s_branch L_O_poll1_e
L_O_poll1:
    s_sleep 6
L_O_poll1_e:
    buffer_load_dword v16, v9, s[40:43], s64 offen sc1
    s_sub_u32 s82, s82, 1
    s_cmp_eq_u32 s82, 0
    s_cselect_b64 s[76:77], 0, -1
    s_waitcnt vmcnt(0)
    v_xor_b32 v16, s60, v16
    v_cmp_ne_u32_sdwa vcc, v16, 0 src0_sel:BYTE_0 src1_sel:DWORD
    s_nop 0
    s_and_b64 vcc, vcc, s[76:77]
    s_cbranch_vccnz L_O_poll1
    v_add_f32_dpp v16, v16, v16 quad_perm:[1,0,3,2] row_mask:0xf bank_mask:0xf
    s_nop 1
    v_add_f32_dpp v16, v16, v16 quad_perm:[2,3,0,1] row_mask:0xf bank_mask:0xf
    v_lshlrev_b32 v24, 16, v24
    v_cvt_pk_bf16_f32 v16, v16, v16
    v_and_b32 v16, 0xffff0000, v16
    v_add_f32 v16, v24, v16
    v_cvt_pk_bf16_f32 v16, v16, v16
    v_and_b32 v16, 0xffff0000, v16
    s_and_b64 exec, s[78:79], s[72:73]
    s_mov_b32 s82, 400000
L_O_poll2:
    buffer_load_dwordx4 v[20:23], v10, s[40:43], s65 offen sc1
    s_sub_u32 s82, s82, 1
    s_cmp_eq_u32 s82, 0
    s_cselect_b64 s[76:77], 0, -1
    s_waitcnt vmcnt(0)
    v_xor_b32 v20, s60, v20
    v_xor_b32 v21, s60, v21
    v_xor_b32 v22, s60, v22
    v_xor_b32 v23, s60, v23
    v_or3_b32 v28, v20, v21, v22
    v_or_b32 v28, v28, v23
    v_cmp_ne_u32_sdwa vcc, v28, 0 src0_sel:BYTE_0 src1_sel:DWORD
    s_nop 0
    s_and_b64 vcc, vcc, s[76:77]
    s_cbranch_vccnz L_O_poll2
    s_mov_b64 exec, s[78:79]
    v_permlane16_swap_b32 v20, v21
    v_permlane16_swap_b32 v22, v23
    v_add_f32 v20, v20, v21
    v_add_f32 v22, v22, v23
    s_nop 1
    v_permlane32_swap_b32 v20, v22
    v_add_f32 v20, v20, v22
    s_nop 1
    v_add_f32_dpp v20, v20, v20 quad_perm:[1,0,3,2] row_mask:0xf bank_mask:0xf
    s_nop 1
    v_add_f32_dpp v20, v20, v20 quad_perm:[2,3,0,1] row_mask:0xf bank_mask:0xf
    s_nop 1
    v_add_f32_dpp v20, v20, v20 row_half_mirror row_mask:0xf bank_mask:0xf
    s_nop 1
    v_add_f32_dpp v20, v20, v20 row_mirror row_mask:0xf bank_mask:0xf
    v_cvt_pk_bf16_f32 v20, v20, v20
    v_and_b32 v20, 0xffff0000, v20
    v_add_f32 v20, v16, v20
    v_cvt_pk_bf16_f32 v20, v20, v20
    s_and_b64 exec, s[78:79], s[74:75]
    buffer_store_short v20, v8, s[92:95], s67 offen
    s_mov_b64 exec, s[78:79]
    s_branch L_exit
L_service:
    s_mov_b32 s56, s16
    s_mov_b32 s57, s17
    s_mov_b32 s58, 2560
    s_mov_b32 s59, 0x20000
    v_mov_b32 v63, 0xff
    s_mov_b32 s7, s2
    s_mov_b32 s14, 16384
    s_movk_i32 s99, 1280
    v_mul_u32_u24 v8, 40, v1
    buffer_load_dwordx2 v[10:11], v8, s[56:59], 0 offen offset:0
    buffer_load_dwordx2 v[14:15], v8, s[56:59], 0 offen offset:8
    buffer_load_dwordx2 v[18:19], v8, s[56:59], 0 offen offset:16
    buffer_load_dwordx2 v[22:23], v8, s[56:59], 0 offen offset:24
    buffer_load_dwordx2 v[26:27], v8, s[56:59], 0 offen offset:32
    s_and_b32 s66, s7, 1
    s_mul_i32 s66, s66, 320
    s_mul_i32 s67, s3, 40
    s_add_u32 s66, s66, s67
    v_lshl_add_u32 v9, v3, 2, v2
    v_lshlrev_b32 v9, 1, v9
    s_lshl_b32 s67, s66, 1
    buffer_load_ushort v30, v9, s[56:59], s67 offen
    buffer_load_ushort v31, v9, s[56:59], s67 offen offset:1280
    s_lshr_b32 s67, s7, 1
    s_lshl_b32 s67, s67, 8
    s_add_u32 s48, s22, s67
    s_addc_u32 s49, s23, 0
    s_mov_b32 s50, 5234944
    s_mov_b32 s51, 0x20000
    v_lshlrev_b32 v8, 13, v2
    v_lshl_add_u32 v8, v3, 4, v8
    s_lshl_b32 s64, s66, 13
    s_mov_b32 s11, 32768
    buffer_load_dwordx4 v[64:67], v8, s[48:51], s64 offen nt
    s_add_u32 s64, s64, s11
    buffer_load_dwordx4 v[68:71], v8, s[48:51], s64 offen nt
    s_add_u32 s64, s64, s11
    buffer_load_dwordx4 v[72:75], v8, s[48:51], s64 offen nt
    s_add_u32 s64, s64, s11
    buffer_load_dwordx4 v[76:79], v8, s[48:51], s64 offen nt
    s_add_u32 s64, s64, s11
    buffer_load_dwordx4 v[80:83], v8, s[48:51], s64 offen nt
    s_add_u32 s64, s64, s11
    buffer_load_dwordx4 v[84:87], v8, s[48:51], s64 offen nt
    s_add_u32 s64, s64, s11
    buffer_load_dwordx4 v[88:91], v8, s[48:51], s64 offen nt
    s_add_u32 s64, s64, s11
    buffer_load_dwordx4 v[92:95], v8, s[48:51], s64 offen nt
    s_add_u32 s64, s64, s11
    buffer_load_dwordx4 v[96:99], v8, s[48:51], s64 offen nt
    s_add_u32 s64, s64, s11
    buffer_load_dwordx4 v[100:103], v8, s[48:51], s64 offen nt
    s_add_u32 s64, s64, s11
    v_lshrrev_b32 v8, 3, v3
    v_mul_u32_u24 v8, 0x0202, v8
    v_add_u32 v8, 0x0100, v8
    v_or_b32 v9, 0x0c0c0000, v8
    v_lshlrev_b32 v8, 16, v8
    v_or_b32 v8, 0x0c0c, v8
    v_and_b32 v57, 1, v3
    v_cmp_eq_u32 vcc, 1, v57
    s_nop 1
    v_cndmask_b32 v8, v9, v8, vcc
    v_bfe_u32 v9, v3, 1, 2
    v_mov_b32 v57, 0x0c0c0c0c
    v_cmp_eq_u32 vcc, 0, v9
    s_nop 1
    v_cndmask_b32 v40, v57, v8, vcc
    v_cmp_eq_u32 vcc, 1, v9
    s_nop 1
    v_cndmask_b32 v41, v57, v8, vcc
    v_cmp_eq_u32 vcc, 2, v9
    s_nop 1
    v_cndmask_b32 v42, v57, v8, vcc
    v_cmp_eq_u32 vcc, 3, v9
    s_nop 1
    v_cndmask_b32 v43, v57, v8, vcc
    s_waitcnt vmcnt(10) lgkmcnt(0)
    s_mul_i32 s12, s12, 0x9E3779B1
    s_add_u32 s12, s12, 0x7F4A7C15
    s_and_b32 s60, s12, 0xff
    v_and_b32 v13, 0xffff0000, v11
    v_lshlrev_b32 v12, 16, v11
    v_and_b32 v11, 0xffff0000, v10
    v_lshlrev_b32 v10, 16, v10
    v_and_b32 v17, 0xffff0000, v15
    v_lshlrev_b32 v16, 16, v15
    v_and_b32 v15, 0xffff0000, v14
    v_lshlrev_b32 v14, 16, v14
    v_and_b32 v21, 0xffff0000, v19
    v_lshlrev_b32 v20, 16, v19
    v_and_b32 v19, 0xffff0000, v18
    v_lshlrev_b32 v18, 16, v18
    v_and_b32 v25, 0xffff0000, v23
    v_lshlrev_b32 v24, 16, v23
    v_and_b32 v23, 0xffff0000, v22
    v_lshlrev_b32 v22, 16, v22
    v_and_b32 v29, 0xffff0000, v27
    v_lshlrev_b32 v28, 16, v27
    v_and_b32 v27, 0xffff0000, v26
    v_lshlrev_b32 v26, 16, v26
    v_pk_add_f32 v[32:33], v[10:11], v[12:13]
    v_pk_add_f32 v[32:33], v[32:33], v[14:15]
    v_pk_add_f32 v[32:33], v[32:33], v[16:17]
    v_pk_add_f32 v[32:33], v[32:33], v[18:19]
    v_pk_add_f32 v[32:33], v[32:33], v[20:21]
    v_pk_add_f32 v[32:33], v[32:33], v[22:23]
    v_pk_add_f32 v[32:33], v[32:33], v[24:25]
    v_pk_add_f32 v[32:33], v[32:33], v[26:27]
    v_pk_add_f32 v[32:33], v[32:33], v[28:29]
    v_add_f32 v32, v32, v33
    s_nop 1
    v_add_f32_dpp v32, v32, v32 quad_perm:[1,0,3,2] row_mask:0xf bank_mask:0xf
    s_nop 1
    v_add_f32_dpp v32, v32, v32 quad_perm:[2,3,0,1] row_mask:0xf bank_mask:0xf
    s_nop 1
    v_add_f32_dpp v32, v32, v32 row_half_mirror row_mask:0xf bank_mask:0xf
    s_nop 1
    v_add_f32_dpp v32, v32, v32 row_mirror row_mask:0xf bank_mask:0xf
    v_mov_b32 v33, v32
    s_nop 1
    v_permlane16_swap_b32 v32, v33
    v_add_f32 v32, v32, v33
    v_mul_f32 v32, 0x3acccccd, v32
    v_pk_add_f32 v[10:11], v[10:11], v[32:33] op_sel_hi:[1,0] neg_lo:[0,1] neg_hi:[0,1]
    v_pk_add_f32 v[12:13], v[12:13], v[32:33] op_sel_hi:[1,0] neg_lo:[0,1] neg_hi:[0,1]
    v_pk_add_f32 v[14:15], v[14:15], v[32:33] op_sel_hi:[1,0] neg_lo:[0,1] neg_hi:[0,1]
    v_pk_add_f32 v[16:17], v[16:17], v[32:33] op_sel_hi:[1,0] neg_lo:[0,1] neg_hi:[0,1]
    v_pk_add_f32 v[18:19], v[18:19], v[32:33] op_sel_hi:[1,0] neg_lo:[0,1] neg_hi:[0,1]
    v_pk_add_f32 v[20:21], v[20:21], v[32:33] op_sel_hi:[1,0] neg_lo:[0,1] neg_hi:[0,1]
    v_pk_add_f32 v[22:23], v[22:23], v[32:33] op_sel_hi:[1,0] neg_lo:[0,1] neg_hi:[0,1]
    v_pk_add_f32 v[24:25], v[24:25], v[32:33] op_sel_hi:[1,0] neg_lo:[0,1] neg_hi:[0,1]
    v_pk_add_f32 v[26:27], v[26:27], v[32:33] op_sel_hi:[1,0] neg_lo:[0,1] neg_hi:[0,1]
    v_pk_add_f32 v[28:29], v[28:29], v[32:33] op_sel_hi:[1,0] neg_lo:[0,1] neg_hi:[0,1]
    v_pk_mul_f32 v[34:35], v[10:11], v[10:11]
    v_pk_fma_f32 v[34:35], v[12:13], v[12:13], v[34:35]
    v_pk_fma_f32 v[34:35], v[14:15], v[14:15], v[34:35]
    v_pk_fma_f32 v[34:35], v[16:17], v[16:17], v[34:35]
    v_pk_fma_f32 v[34:35], v[18:19], v[18:19], v[34:35]
    v_pk_fma_f32 v[34:35], v[20:21], v[20:21], v[34:35]
    v_pk_fma_f32 v[34:35], v[22:23], v[22:23], v[34:35]
    v_pk_fma_f32 v[34:35], v[24:25], v[24:25], v[34:35]
    v_pk_fma_f32 v[34:35], v[26:27], v[26:27], v[34:35]
    v_pk_fma_f32 v[34:35], v[28:29], v[28:29], v[34:35]
    v_add_f32 v34, v34, v35
    s_nop 1
    v_add_f32_dpp v34, v34, v34 quad_perm:[1,0,3,2] row_mask:0xf bank_mask:0xf
    s_nop 1
    v_add_f32_dpp v34, v34, v34 quad_perm:[2,3,0,1] row_mask:0xf bank_mask:0xf
    s_nop 1
    v_add_f32_dpp v34, v34, v34 row_half_mirror row_mask:0xf bank_mask:0xf
    s_nop 1
    v_add_f32_dpp v34, v34, v34 row_mirror row_mask:0xf bank_mask:0xf
    v_mov_b32 v33, v34
    s_nop 1
    v_permlane16_swap_b32 v34, v33
    v_add_f32 v34, v34, v33
    v_mul_f32 v34, 0x3acccccd, v34
    v_cvt_pk_bf16_f32 v34, v34, v34
    v_and_b32 v34, 0xffff0000, v34
    v_add_f32 v34, 0x3727c5ac, v34
    v_cvt_pk_bf16_f32 v34, v34, v34
    v_and_b32 v34, 0xffff0000, v34
    v_sqrt_f32 v34, v34
    v_cvt_pk_bf16_f32 v32, v32, v32
    v_and_b32 v32, 0xffff0000, v32
    v_cvt_pk_bf16_f32 v34, v34, v34
    v_and_b32 v34, 0xffff0000, v34
    v_rcp_f32 v36, v34
    v_mov_b32 v33, v32
    v_mov_b32 v35, v34
    v_mov_b32 v37, v36
    v_permlane32_swap_b32 v32, v33
    v_permlane32_swap_b32 v34, v35
    v_permlane32_swap_b32 v36, v37
    v_lshlrev_b32 v30, 16, v30
    v_lshlrev_b32 v31, 16, v31
    v_sub_f32 v30, v30, v32
    v_sub_f32 v31, v31, v33
    v_cvt_pk_bf16_f32 v30, v30, v30
    v_and_b32 v30, 0xffff0000, v30
    v_cvt_pk_bf16_f32 v31, v31, v31
    v_and_b32 v31, 0xffff0000, v31
    v_mul_f32 v38, v30, v36
    v_mul_f32 v39, v31, v37
    v_fma_f32 v30, -v38, v34, v30
    v_fma_f32 v31, -v39, v35, v31
    v_fma_f32 v30, v30, v36, v38
    v_fma_f32 v31, v31, v37, v39
    v_cvt_pk_bf16_f32 v30, v30, v31
    s_nop 1
    v_mov_b32_dpp v31, v30 row_newbcast:0 row_mask:0xf bank_mask:0xf
    v_perm_b32 v48, v31, v31, v40
    v_perm_b32 v49, v31, v31, v41
    v_perm_b32 v50, v31, v31, v42
    v_perm_b32 v51, v31, v31, v43
    s_waitcnt vmcnt(9)
    s_nop 0
    v_mfma_f32_16x16x32_bf16 v[44:47], v[48:51], v[64:67], 0
    v_mov_b32_dpp v31, v30 row_newbcast:1 row_mask:0xf bank_mask:0xf
    v_perm_b32 v52, v31, v31, v40
    v_perm_b32 v53, v31, v31, v41
    v_perm_b32 v54, v31, v31, v42
    v_perm_b32 v55, v31, v31, v43
    s_waitcnt vmcnt(8)
    s_nop 0
    v_mfma_f32_16x16x32_bf16 v[44:47], v[52:55], v[68:71], v[44:47]
    v_mov_b32_dpp v31, v30 row_newbcast:2 row_mask:0xf bank_mask:0xf
    v_perm_b32 v48, v31, v31, v40
    v_perm_b32 v49, v31, v31, v41
    v_perm_b32 v50, v31, v31, v42
    v_perm_b32 v51, v31, v31, v43
    s_waitcnt vmcnt(7)
    s_nop 0
    v_mfma_f32_16x16x32_bf16 v[44:47], v[48:51], v[72:75], v[44:47]
    v_mov_b32_dpp v31, v30 row_newbcast:3 row_mask:0xf bank_mask:0xf
    v_perm_b32 v52, v31, v31, v40
    v_perm_b32 v53, v31, v31, v41
    v_perm_b32 v54, v31, v31, v42
    v_perm_b32 v55, v31, v31, v43
    s_waitcnt vmcnt(6)
    s_nop 0
    v_mfma_f32_16x16x32_bf16 v[44:47], v[52:55], v[76:79], v[44:47]
    v_mov_b32_dpp v31, v30 row_newbcast:4 row_mask:0xf bank_mask:0xf
    v_perm_b32 v48, v31, v31, v40
    v_perm_b32 v49, v31, v31, v41
    v_perm_b32 v50, v31, v31, v42
    v_perm_b32 v51, v31, v31, v43
    s_waitcnt vmcnt(5)
    s_nop 0
    v_mfma_f32_16x16x32_bf16 v[44:47], v[48:51], v[80:83], v[44:47]
    v_mov_b32_dpp v31, v30 row_newbcast:5 row_mask:0xf bank_mask:0xf
    v_perm_b32 v52, v31, v31, v40
    v_perm_b32 v53, v31, v31, v41
    v_perm_b32 v54, v31, v31, v42
    v_perm_b32 v55, v31, v31, v43
    s_waitcnt vmcnt(4)
    s_nop 0
    v_mfma_f32_16x16x32_bf16 v[44:47], v[52:55], v[84:87], v[44:47]
    v_mov_b32_dpp v31, v30 row_newbcast:6 row_mask:0xf bank_mask:0xf
    v_perm_b32 v48, v31, v31, v40
    v_perm_b32 v49, v31, v31, v41
    v_perm_b32 v50, v31, v31, v42
    v_perm_b32 v51, v31, v31, v43
    s_waitcnt vmcnt(3)
    s_nop 0
    v_mfma_f32_16x16x32_bf16 v[44:47], v[48:51], v[88:91], v[44:47]
    v_mov_b32_dpp v31, v30 row_newbcast:7 row_mask:0xf bank_mask:0xf
    v_perm_b32 v52, v31, v31, v40
    v_perm_b32 v53, v31, v31, v41
    v_perm_b32 v54, v31, v31, v42
    v_perm_b32 v55, v31, v31, v43
    s_waitcnt vmcnt(2)
    s_nop 0
    v_mfma_f32_16x16x32_bf16 v[44:47], v[52:55], v[92:95], v[44:47]
    v_mov_b32_dpp v31, v30 row_newbcast:8 row_mask:0xf bank_mask:0xf
    v_perm_b32 v48, v31, v31, v40
    v_perm_b32 v49, v31, v31, v41
    v_perm_b32 v50, v31, v31, v42
    v_perm_b32 v51, v31, v31, v43
    s_waitcnt vmcnt(1)
    s_nop 0
    v_mfma_f32_16x16x32_bf16 v[44:47], v[48:51], v[96:99], v[44:47]
    v_mov_b32_dpp v31, v30 row_newbcast:9 row_mask:0xf bank_mask:0xf
    v_perm_b32 v52, v31, v31, v40
    v_perm_b32 v53, v31, v31, v41
    v_perm_b32 v54, v31, v31, v42
    v_perm_b32 v55, v31, v31, v43
    s_waitcnt vmcnt(0)
    s_nop 0
    v_mfma_f32_16x16x32_bf16 v[44:47], v[52:55], v[100:103], v[44:47]
    v_lshlrev_b32 v8, 4, v0
    s_nop 6
    ds_write_b128 v8, v[44:47] offset:16384
    s_waitcnt lgkmcnt(0)
    s_barrier
    s_cmp_lg_u32 s3, 0
    s_cbranch_scc1 L_s_nopub
    ds_read_b128 v[64:67], v8 offset:16384
    ds_read_b128 v[68:71], v8 offset:17408
    ds_read_b128 v[72:75], v8 offset:18432
    ds_read_b128 v[76:79], v8 offset:19456
    ds_read_b128 v[80:83], v8 offset:20480
    ds_read_b128 v[84:87], v8 offset:21504
    ds_read_b128 v[88:91], v8 offset:22528
    ds_read_b128 v[92:95], v8 offset:23552
    s_lshl_b32 s66, s7, 10
    s_add_u32 s66, s66, 294912
    s_waitcnt lgkmcnt(0)
    v_pk_add_f32 v[64:65], v[64:65], v[68:69]
    v_pk_add_f32 v[66:67], v[66:67], v[70:71]
    v_pk_add_f32 v[72:73], v[72:73], v[76:77]
    v_pk_add_f32 v[74:75], v[74:75], v[78:79]
    v_pk_add_f32 v[80:81], v[80:81], v[84:85]
    v_pk_add_f32 v[82:83], v[82:83], v[86:87]
    v_pk_add_f32 v[88:89], v[88:89], v[92:93]
    v_pk_add_f32 v[90:91], v[90:91], v[94:95]
    v_pk_add_f32 v[64:65], v[64:65], v[72:73]
    v_pk_add_f32 v[66:67], v[66:67], v[74:75]
    v_pk_add_f32 v[80:81], v[80:81], v[88:89]
    v_pk_add_f32 v[82:83], v[82:83], v[90:91]
    v_pk_add_f32 v[64:65], v[64:65], v[80:81]
    v_pk_add_f32 v[66:67], v[66:67], v[82:83]
    v_add_u32 v64, 8, v64
    v_add_u32 v65, 8, v65
    v_add_u32 v66, 8, v66
    v_add_u32 v67, 8, v67
    v_bfi_b32 v64, 15, s12, v64
    v_bfi_b32 v65, 15, s12, v65
    v_bfi_b32 v66, 15, s12, v66
    v_bfi_b32 v67, 15, s12, v67
    buffer_store_dwordx4 v[64:67], v8, s[40:43], s66 offen sc1
L_s_nopub:
    s_barrier
    v_lshlrev_b32 v8, 2, v0
    v_mov_b32 v9, 0x3f803f80
    v_mov_b32 v10, 0
    ds_write_b32 v8, v10 offset:11008
    v_mov_b32 v9, -1
    v_cmp_gt_u32 vcc, 256, v0
    s_nop 0
    s_and_b64 exec, exec, vcc
    ds_write_b32 v8, v9 offset:9600
    v_cmp_gt_u32 vcc, 128, v0
    s_nop 0
    s_and_b64 exec, exec, vcc
    ds_write_b32 v8, v10 offset:13568
    s_mov_b64 exec, -1
    s_sub_u32 s81, s7, 27
    s_mov_b32 s80, s7
    s_lshr_b32 s68, s3, 1
    s_and_b32 s68, s68, 1
    s_lshl_b32 s68, s68, 3
    v_lshlrev_b32 v9, 1, v2
    v_or_b32 v9, s68, v9
    v_xor_b32 v9, v9, v3
    v_lshlrev_b32 v9, 4, v9
    v_mul_u32_u24 v4, 1280, v2
    v_add_u32 v4, v4, v9
    v_lshrrev_b32 v12, 2, v1
    v_and_b32 v12, 7, v12
    v_lshlrev_b32 v12, 1, v12
    v_bfe_u32 v13, v1, 1, 1
    v_xor_b32 v12, v12, v13
    v_lshlrev_b32 v12, 4, v12
    v_and_b32 v13, 1, v1
    v_lshl_add_u32 v12, v13, 3, v12
    v_bfe_u32 v13, v1, 2, 2
    v_lshl_add_u32 v13, v2, 3, v13
    v_lshl_add_u32 v5, v13, 8, v12
    s_and_b32 s68, s3, 1
    s_lshl_b32 s68, s68, 1
    s_and_b32 s69, s3, 4
    s_or_b32 s68, s68, s69
    v_and_b32 v9, 1, v2
    v_or_b32 v9, s68, v9
    v_and_b32 v10, 7, v1
    v_xor_b32 v9, v9, v10
    v_lshrrev_b32 v8, 3, v1
    v_mul_u32_u24 v8, 3456, v8
    v_lshl_add_u32 v6, v9, 4, v8
    v_bfe_u32 v13, v1, 3, 2
    v_bfe_u32 v14, v1, 1, 1
    v_lshl_add_u32 v13, v14, 2, v13
    v_xor_b32 v13, s3, v13
    v_lshlrev_b32 v13, 4, v13
    v_mul_u32_u24 v14, 20480, v14
    v_add3_u32 v13, v13, v14, s14
    v_and_b32 v14, 1, v1
    v_lshl_add_u32 v13, v14, 3, v13
    v_bfe_u32 v14, v1, 2, 2
    v_lshl_add_u32 v14, v2, 3, v14
    v_lshl_add_u32 v7, v14, 7, v13
    s_mul_i32 s66, s3, 5
    v_lshrrev_b32 v36, 3, v1
    v_add_u32 v36, s66, v36
    v_and_b32 v37, 3, v1
    v_lshl_add_u32 v36, v36, 2, v37
    v_lshlrev_b32 v36, 3, v36
    v_bfe_u32 v37, v1, 2, 1
    v_mad_u32_u24 v8, v37, s99, v36
    buffer_load_dwordx2 v[48:49], v8, s[56:59], 0 offen
    v_mul_u32_u24 v9, 1344, v37
    v_lshrrev_b32 v38, 1, v36
    v_add_u32 v9, v9, v38
    v_add_u32 v9, 6912, v9
    v_lshrrev_b32 v8, 5, v36
    v_lshlrev_b32 v8, 3, v8
    v_lshl_add_u32 v8, v37, 9, v8
    v_lshlrev_b32 v10, 4, v1
    s_mul_i32 s90, s3, 640
    s_add_u32 s90, s90, 102400
    s_add_u32 s91, s90, 5120
    s_add_u32 s92, s90, 10240
    s_add_u32 s93, s90, 15360
    v_bfe_u32 v11, v3, 2, 1
    v_and_b32 v36, 1, v3
    v_mul_u32_u24 v11, 1344, v11
    v_lshl_add_u32 v11, v2, 4, v11
    v_lshrrev_b32 v37, 3, v3
    v_lshl_add_u32 v37, v36, 1, v37
    v_mul_u32_u24 v37, 320, v37
    v_add_u32 v11, v11, v37
    v_and_b32 v12, 1, v2
    v_lshlrev_b32 v12, 6, v12
    v_lshrrev_b32 v37, 1, v2
    v_lshl_add_u32 v12, v37, 4, v12
    v_add_u32 v12, v12, v3
    v_lshlrev_b32 v12, 3, v12
    v_add_u32 v12, 11008, v12
    v_and_b32 v13, 1, v2
    v_lshlrev_b32 v13, 6, v13
    v_bfe_u32 v37, v3, 1, 1
    v_lshl_add_u32 v13, v37, 7, v13
    v_lshl_add_u32 v13, v36, 1, v13
    v_and_b32 v38, 4, v3
    v_add_u32 v13, v13, v38
    s_lshl_b32 s66, s3, 3
    v_add_u32 v13, s66, v13
    v_mov_b32 v38, 0x4444
    v_mov_b32 v39, 0xeeee
    v_cmp_eq_u32 vcc, 1, v37
    s_nop 1
    v_cndmask_b32 v46, v38, v39, vcc
    v_cmp_eq_u32 vcc, 1, v36
    s_nop 1
    v_cndmask_b32 v15, v38, v39, vcc
    v_and_b32 v42, 3, v3
    v_lshlrev_b32 v42, 6, v42
    v_lshl_add_u32 v42, v2, 4, v42
    s_mul_i32 s98, s80, 5120
    s_mul_i32 s68, s3, 640
    s_add_u32 s98, s98, s68
    s_add_u32 s98, s98, 143360
    v_lshlrev_b32 v14, 6, v3
    v_lshl_add_u32 v14, v2, 4, v14
    v_lshlrev_b32 v54, 3, v1
    v_mov_b32 v55, 0
    v_lshrrev_b32 v36, 5, v1
    v_and_b32 v37, 31, v1
    v_mul_u32_u24 v16, 49152, v36
    v_lshl_add_u32 v16, v37, 4, v16
    v_lshlrev_b32 v17, 11, v36
    s_lshl_b32 s68, s3, 8
    s_add_u32 s68, s68, 4352
    v_mul_u32_u24 v18, 2112, v36
    v_lshl_add_u32 v18, v37, 2, v18
    v_add_u32 v18, s68, v18
    v_bfe_u32 v19, v3, 2, 1
    v_mul_u32_u24 v19, 2112, v19
    v_lshl_add_u32 v19, v2, 4, v19
    v_and_b32 v36, 1, v3
    v_lshl_add_u32 v19, v36, 7, v19
    v_lshrrev_b32 v36, 3, v3
    v_lshl_add_u32 v19, v36, 6, v19
    s_lshr_b32 s68, s3, 2
    s_lshl_b32 s69, s68, 10
    v_add_u32 v19, s69, v19
    v_lshlrev_b32 v58, 2, v1
    s_and_b32 s69, s3, 3
    s_lshl_b32 s66, s69, 7
    v_add_u32 v20, s66, v58
    v_bfe_u32 v22, v1, 3, 2
    v_xor_b32 v22, s69, v22
    v_lshlrev_b32 v22, 5, v22
    v_and_b32 v36, 3, v1
    v_lshl_add_u32 v22, v36, 3, v22
    v_bfe_u32 v36, v1, 2, 2
    v_lshl_add_u32 v36, v2, 3, v36
    v_lshl_add_u32 v22, v36, 7, v22
    s_lshl_b32 s68, s68, 16
    s_add_u32 s68, s68, 16384
    v_add_u32 v22, s68, v22
    s_and_b32 s68, s3, 1
    s_lshl_b32 s68, s68, 2
    v_and_b32 v21, 1, v2
    v_lshlrev_b32 v21, 1, v21
    v_or_b32 v21, s68, v21
    v_and_b32 v36, 7, v1
    v_xor_b32 v21, v21, v36
    v_lshlrev_b32 v21, 4, v21
    v_lshrrev_b32 v36, 3, v1
    v_mul_u32_u24 v36, 1280, v36
    v_add_u32 v21, v21, v36
    v_lshlrev_b32 v59, 6, v1
    s_lshl_b32 s68, 1, s3
    v_mov_b32 v52, s68
    s_min_u32 s68, s81, 63
    s_mul_i32 s66, s68, 57
    s_lshr_b32 s66, s66, 9
    s_min_u32 s66, s66, 3
    s_mul_i32 s67, s66, 9
    s_sub_u32 s67, s68, s67
    s_cmp_lt_u32 s81, 27
    s_cselect_b32 s69, s67, 0
    s_cmp_eq_u32 s69, 8
    s_cselect_b32 s8, 1, 0
    s_lshl_b32 s68, s66, 4
    s_add_u32 s68, s68, s3
    s_mul_i32 s9, s68, 10240
    s_lshl_b32 s68, s67, 7
    s_add_u32 s9, s9, s68
    s_lshl_b32 s68, s3, 2
    s_add_u32 s68, s68, s66
    s_mul_i32 s5, s68, 1536
    s_lshl_b32 s6, s68, 6
    s_add_u32 s6, s6, 98304
    s_mul_i32 s4, s66, 5120
    s_lshl_b32 s67, s67, 9
    s_add_u32 s4, s4, s67
    s_add_u32 s4, s4, 102400
    s_and_b32 s67, s3, 3
    s_lshl_b32 s67, s67, 7
    s_add_u32 s4, s4, s67
    s_and_b32 s61, s3, 4
    s_waitcnt vmcnt(0)
    v_and_b32 v51, 0xffff0000, v49
    v_lshlrev_b32 v50, 16, v49
    v_and_b32 v49, 0xffff0000, v48
    v_lshlrev_b32 v48, 16, v48
    s_cmp_eq_u32 s8, 0
    s_cbranch_scc1 L_s_e1
    s_mov_b32 s48, s24
    s_mov_b32 s49, s25
    s_mov_b32 s50, 5242880
    s_mov_b32 s51, 0x20000
    s_add_u32 s64, s9, 128
    s_lshl_b32 s67, s3, 10
    s_add_u32 m0, s67, 16384
    s_nop 0
    buffer_load_dwordx4 v21, s[48:51], s64 offen nt lds
    s_add_u32 s64, s64, 81920
    s_add_u32 m0, m0, 8192
    s_nop 0
    buffer_load_dwordx4 v21, s[48:51], s64 offen nt lds
    s_add_u32 s64, s64, 573440
    s_add_u32 m0, m0, 8192
    s_nop 0
    buffer_load_dwordx4 v21, s[48:51], s64 offen nt lds
    s_add_u32 s64, s64, 81920
    s_add_u32 m0, m0, 8192
    s_nop 0
    buffer_load_dwordx4 v21, s[48:51], s64 offen nt lds
    s_add_u32 s64, s64, 573440
    s_add_u32 m0, m0, 8192
    s_nop 0
    buffer_load_dwordx4 v21, s[48:51], s64 offen nt lds
    s_add_u32 s64, s64, 81920
    s_add_u32 m0, m0, 8192
    s_nop 0
    buffer_load_dwordx4 v21, s[48:51], s64 offen nt lds
    s_add_u32 s64, s64, 573440
    s_add_u32 m0, m0, 8192
    s_nop 0
    buffer_load_dwordx4 v21, s[48:51], s64 offen nt lds
    s_add_u32 s64, s64, 81920
    s_add_u32 m0, m0, 8192
    s_nop 0
    buffer_load_dwordx4 v21, s[48:51], s64 offen nt lds
    s_add_u32 s64, s64, 573440
    s_add_u32 m0, m0, 8192
    s_nop 0
    buffer_load_dwordx4 v21, s[48:51], s64 offen nt lds
    s_add_u32 s64, s64, 81920
    s_add_u32 m0, m0, 8192
    s_nop 0
    buffer_load_dwordx4 v21, s[48:51], s64 offen nt lds
    s_add_u32 s64, s64, 573440
    s_add_u32 m0, m0, 8192
    s_nop 0
    buffer_load_dwordx4 v21, s[48:51], s64 offen nt lds
    s_add_u32 s64, s64, 81920
    s_add_u32 m0, m0, 8192
    s_nop 0
    buffer_load_dwordx4 v21, s[48:51], s64 offen nt lds
    s_add_u32 s64, s64, 573440
    s_add_u32 m0, m0, 8192
    s_nop 0
    buffer_load_dwordx4 v21, s[48:51], s64 offen nt lds
    s_add_u32 s64, s64, 81920
    s_add_u32 m0, m0, 8192
    s_nop 0
    buffer_load_dwordx4 v21, s[48:51], s64 offen nt lds
    s_add_u32 s64, s64, 573440
    s_add_u32 m0, m0, 8192
    s_nop 0
    buffer_load_dwordx4 v21, s[48:51], s64 offen nt lds
    s_add_u32 s64, s64, 81920
    s_add_u32 m0, m0, 8192
    s_nop 0
    buffer_load_dwordx4 v21, s[48:51], s64 offen nt lds
    s_add_u32 s64, s64, 573440
    s_add_u32 m0, m0, 8192
    s_waitcnt vmcnt(0)
    s_barrier
    ds_read_b64_tr_b16 v[64:65], v22 offset:0
    ds_read_b64_tr_b16 v[66:67], v22 offset:512
    ds_read_b64_tr_b16 v[68:69], v22 offset:4096
    ds_read_b64_tr_b16 v[70:71], v22 offset:4608
    ds_read_b64_tr_b16 v[72:73], v22 offset:8192
    ds_read_b64_tr_b16 v[74:75], v22 offset:8704
    ds_read_b64_tr_b16 v[76:77], v22 offset:12288
    ds_read_b64_tr_b16 v[78:79], v22 offset:12800
    ds_read_b64_tr_b16 v[80:81], v22 offset:16384
    ds_read_b64_tr_b16 v[82:83], v22 offset:16896
    ds_read_b64_tr_b16 v[84:85], v22 offset:20480
    ds_read_b64_tr_b16 v[86:87], v22 offset:20992
    ds_read_b64_tr_b16 v[88:89], v22 offset:24576
    ds_read_b64_tr_b16 v[90:91], v22 offset:25088
    ds_read_b64_tr_b16 v[92:93], v22 offset:28672
    ds_read_b64_tr_b16 v[94:95], v22 offset:29184
    ds_read_b64_tr_b16 v[96:97], v22 offset:32768
    ds_read_b64_tr_b16 v[98:99], v22 offset:33280
    ds_read_b64_tr_b16 v[100:101], v22 offset:36864
    ds_read_b64_tr_b16 v[102:103], v22 offset:37376
    ds_read_b64_tr_b16 v[104:105], v22 offset:40960
    ds_read_b64_tr_b16 v[106:107], v22 offset:41472
    ds_read_b64_tr_b16 v[108:109], v22 offset:45056
    ds_read_b64_tr_b16 v[110:111], v22 offset:45568
    ds_read_b64_tr_b16 v[112:113], v22 offset:49152
    ds_read_b64_tr_b16 v[114:115], v22 offset:49664
    ds_read_b64_tr_b16 v[116:117], v22 offset:53248
    ds_read_b64_tr_b16 v[118:119], v22 offset:53760
    ds_read_b64_tr_b16 v[120:121], v22 offset:57344
    ds_read_b64_tr_b16 v[122:123], v22 offset:57856
    ds_read_b64_tr_b16 v[124:125], v22 offset:61440
    ds_read_b64_tr_b16 v[126:127], v22 offset:61952
L_s_e1:
    s_waitcnt lgkmcnt(0)
    s_barrier
    s_mov_b32 s83, 2
    s_mov_b64 s[78:79], 0
    s_mov_b64 exec, 0
L_s_tail:
    s_cmp_ge_u32 s81, 40
    s_cselect_b32 s67, 50, 62
    s_mov_b32 s66, 98304
    s_cmp_lg_u32 s3, 0
    s_cbranch_scc1 L_s_trigx
    s_mov_b32 s82, 400000
    s_branch L_s_trig_e
L_s_trig:
    s_sleep 3
L_s_trig_e:
    s_cbranch_execz L_vm5
    buffer_load_dword v32, v59, s[40:43], s66 offen offset:4 sc1
L_vm5:
    s_sub_u32 s82, s82, 1
    s_cmp_eq_u32 s82, 0
    s_cselect_b64 s[76:77], 0, -1
    s_waitcnt vmcnt(0)
    v_cmp_ne_u32 vcc, s12, v32
    s_nop 0
    s_bcnt1_i32_b64 s68, vcc
    s_cmp_gt_u32 s68, s67
    s_cselect_b64 vcc, -1, 0
    s_and_b64 vcc, vcc, s[76:77]
    s_cbranch_vccnz L_s_trig
L_s_trigx:
    s_cbranch_execz L_nb1
    s_barrier
L_nb1:
    s_cmp_lt_u32 s81, 40
    s_cbranch_scc1 L_R
    s_cbranch_execz L_F
    s_mov_b32 s48, s28
    s_mov_b32 s49, s29
    s_mov_b32 s50, 2211840
    s_mov_b32 s51, 0x20000
    s_mov_b32 s44, s32
    s_mov_b32 s45, s33
    s_mov_b32 s46, 2211840
    s_mov_b32 s47, 0x20000
    s_cmp_ge_u32 s3, 4
    s_cselect_b32 s48, s30, s48
    s_cselect_b32 s49, s31, s49
    s_and_b32 s66, s3, 3
    s_mul_i32 s64, s66, 27648
    s_lshl_b32 s67, s80, 7
    s_add_u32 s64, s64, s67
    s_lshl_b32 s66, s66, 10
    s_lshr_b32 s67, s3, 2
    s_mul_i32 s67, s67, 20480
    s_add_u32 s66, s66, s67
    s_mul_i32 s65, s80, 81920
    s_mul_i32 s67, s3, 5120
    s_add_u32 s65, s65, s67
    s_lshl_b32 s67, s3, 10
    s_add_u32 m0, s66, 16384
    s_nop 0
    buffer_load_dwordx4 v6, s[48:51], s64 offen nt lds
    s_add_u32 s64, s64, 110592
    s_add_u32 m0, s66, 20480
    s_nop 0
    buffer_load_dwordx4 v6, s[48:51], s64 offen nt lds
    s_add_u32 s64, s64, 110592
    s_add_u32 m0, s66, 24576
    s_nop 0
    buffer_load_dwordx4 v6, s[48:51], s64 offen nt lds
    s_add_u32 s64, s64, 110592
    s_add_u32 m0, s66, 28672
    s_nop 0
    buffer_load_dwordx4 v6, s[48:51], s64 offen nt lds
    s_add_u32 s64, s64, 110592
    s_add_u32 m0, s66, 32768
    s_nop 0
    buffer_load_dwordx4 v6, s[48:51], s64 offen nt lds
    s_add_u32 s64, s64, 110592
    s_add_u32 m0, s66, 57344
    s_nop 0
    buffer_load_dwordx4 v6, s[48:51], s64 offen nt lds
    s_add_u32 s64, s64, 110592
    s_add_u32 m0, s66, 61440
    s_nop 0
    buffer_load_dwordx4 v6, s[48:51], s64 offen nt lds
    s_add_u32 s64, s64, 110592
    s_add_u32 m0, s66, 65536
    s_nop 0
    buffer_load_dwordx4 v6, s[48:51], s64 offen nt lds
    s_add_u32 s64, s64, 110592
    s_add_u32 m0, s66, 69632
    s_nop 0
    buffer_load_dwordx4 v6, s[48:51], s64 offen nt lds
    s_add_u32 s64, s64, 110592
    s_add_u32 m0, s66, 73728
    s_nop 0
    buffer_load_dwordx4 v6, s[48:51], s64 offen nt lds
    s_add_u32 s64, s64, 110592
    s_add_u32 m0, s66, 98304
    s_nop 0
    buffer_load_dwordx4 v6, s[48:51], s64 offen nt lds
    s_add_u32 s64, s64, 110592
    s_add_u32 m0, s66, 102400
    s_nop 0
    buffer_load_dwordx4 v6, s[48:51], s64 offen nt lds
    s_add_u32 s64, s64, 110592
    s_add_u32 m0, s66, 106496
    s_nop 0
    buffer_load_dwordx4 v6, s[48:51], s64 offen nt lds
    s_add_u32 s64, s64, 110592
    s_add_u32 m0, s66, 110592
    s_nop 0
    buffer_load_dwordx4 v6, s[48:51], s64 offen nt lds
    s_add_u32 s64, s64, 110592
    s_add_u32 m0, s66, 114688
    s_nop 0
    buffer_load_dwordx4 v6, s[48:51], s64 offen nt lds
    s_add_u32 s64, s64, 110592
    s_mul_i32 s68, s3, 5
    s_add_u32 s68, s68, 0
    s_and_b32 s69, s68, 7
    s_lshl_b32 s69, s69, 5
    v_xor_b32 v232, s69, v5
    s_lshr_b32 s68, s68, 3
    s_lshl_b32 s68, s68, 13
    s_add_u32 s68, s68, 57344
    v_add_u32 v232, s68, v232
    s_mul_i32 s68, s3, 5
    s_add_u32 s68, s68, 1
    s_and_b32 s69, s68, 7
    s_lshl_b32 s69, s69, 5
    v_xor_b32 v233, s69, v5
    s_lshr_b32 s68, s68, 3
    s_lshl_b32 s68, s68, 13
    s_add_u32 s68, s68, 57344
    v_add_u32 v233, s68, v233
    s_mul_i32 s68, s3, 5
    s_add_u32 s68, s68, 2
    s_and_b32 s69, s68, 7
    s_lshl_b32 s69, s69, 5
    v_xor_b32 v234, s69, v5
    s_lshr_b32 s68, s68, 3
    s_lshl_b32 s68, s68, 13
    s_add_u32 s68, s68, 57344
    v_add_u32 v234, s68, v234
    s_mul_i32 s68, s3, 5
    s_add_u32 s68, s68, 3
    s_and_b32 s69, s68, 7
    s_lshl_b32 s69, s69, 5
    v_xor_b32 v235, s69, v5
    s_lshr_b32 s68, s68, 3
    s_lshl_b32 s68, s68, 13
    s_add_u32 s68, s68, 57344
    v_add_u32 v235, s68, v235
    s_mul_i32 s68, s3, 5
    s_add_u32 s68, s68, 4
    s_and_b32 s69, s68, 7
    s_lshl_b32 s69, s69, 5
    v_xor_b32 v236, s69, v5
    s_lshr_b32 s68, s68, 3
    s_lshl_b32 s68, s68, 13
    s_add_u32 s68, s68, 57344
    v_add_u32 v236, s68, v236
    v_add_u32 v237, 81920, v7
    v_mov_b32 v240, 0x3f803f80
    v_mov_b32 v241, 0x3f803f80
    v_mov_b32 v242, 0x3f803f80
    v_mov_b32 v243, 0x3f803f80
    s_waitcnt vmcnt(10)
    s_barrier
    ds_read_b64_tr_b16 v[64:65], v7 offset:0
    ds_read_b64_tr_b16 v[66:67], v7 offset:512
    ds_read_b64_tr_b16 v[68:69], v7 offset:4096
    ds_read_b64_tr_b16 v[70:71], v7 offset:4608
    ds_read_b64_tr_b16 v[72:73], v7 offset:8192
    ds_read_b64_tr_b16 v[74:75], v7 offset:8704
    ds_read_b64_tr_b16 v[76:77], v7 offset:12288
    ds_read_b64_tr_b16 v[78:79], v7 offset:12800
    ds_read_b64_tr_b16 v[80:81], v7 offset:16384
    ds_read_b64_tr_b16 v[82:83], v7 offset:16896
    s_waitcnt lgkmcnt(0)
    s_barrier
    s_add_u32 m0, s66, 16384
    s_nop 0
    buffer_load_dwordx4 v6, s[48:51], s64 offen nt lds
    s_add_u32 s64, s64, 110592
    s_add_u32 m0, s66, 20480
    s_nop 0
    buffer_load_dwordx4 v6, s[48:51], s64 offen nt lds
    s_add_u32 s64, s64, 110592
    s_add_u32 m0, s66, 24576
    s_nop 0
    buffer_load_dwordx4 v6, s[48:51], s64 offen nt lds
    s_add_u32 s64, s64, 110592
    s_add_u32 m0, s66, 28672
    s_nop 0
    buffer_load_dwordx4 v6, s[48:51], s64 offen nt lds
    s_add_u32 s64, s64, 110592
    s_add_u32 m0, s66, 32768
    s_nop 0
    buffer_load_dwordx4 v6, s[48:51], s64 offen nt lds
    s_add_u32 s64, s64, 110592
    s_waitcnt lgkmcnt(0)
    v_mfma_f32_16x16x32_bf16 v[244:247], v[240:243], v[64:67], 0
    v_mfma_f32_16x16x32_bf16 v[244:247], v[240:243], v[68:71], v[244:247]
    v_mfma_f32_16x16x32_bf16 v[244:247], v[240:243], v[72:75], v[244:247]
    v_mfma_f32_16x16x32_bf16 v[244:247], v[240:243], v[76:79], v[244:247]
    v_mfma_f32_16x16x32_bf16 v[244:247], v[240:243], v[80:83], v[244:247]
    s_waitcnt vmcnt(10)
    s_barrier
    ds_read_b64_tr_b16 v[84:85], v7 offset:40960
    ds_read_b64_tr_b16 v[86:87], v7 offset:41472
    ds_read_b64_tr_b16 v[88:89], v7 offset:45056
    ds_read_b64_tr_b16 v[90:91], v7 offset:45568
    ds_read_b64_tr_b16 v[92:93], v7 offset:49152
    ds_read_b64_tr_b16 v[94:95], v7 offset:49664
    ds_read_b64_tr_b16 v[96:97], v7 offset:53248
    ds_read_b64_tr_b16 v[98:99], v7 offset:53760
    ds_read_b64_tr_b16 v[100:101], v7 offset:57344
    ds_read_b64_tr_b16 v[102:103], v7 offset:57856
    s_waitcnt lgkmcnt(0)
    s_barrier
    s_add_u32 m0, s67, 57344
    s_nop 0
    buffer_load_dwordx4 v4, s[44:47], s65 offen nt lds
    s_add_u32 s65, s65, 256
    s_add_u32 m0, s67, 65536
    s_nop 0
    buffer_load_dwordx4 v4, s[44:47], s65 offen nt lds
    s_add_u32 s65, s65, 256
    s_add_u32 m0, s67, 73728
    s_nop 0
    buffer_load_dwordx4 v4, s[44:47], s65 offen nt lds
    s_add_u32 s65, s65, 256
    s_add_u32 m0, s67, 81920
    s_nop 0
    buffer_load_dwordx4 v4, s[44:47], s65 offen nt lds
    s_add_u32 s65, s65, 256
    s_add_u32 m0, s67, 90112
    s_nop 0
    buffer_load_dwordx4 v4, s[44:47], s65 offen nt lds
    s_add_u32 s65, s65, 39936
    s_waitcnt lgkmcnt(0)
    v_mfma_f32_16x16x32_bf16 v[244:247], v[240:243], v[84:87], v[244:247]
    v_mfma_f32_16x16x32_bf16 v[244:247], v[240:243], v[88:91], v[244:247]
    v_mfma_f32_16x16x32_bf16 v[244:247], v[240:243], v[92:95], v[244:247]
    v_mfma_f32_16x16x32_bf16 v[244:247], v[240:243], v[96:99], v[244:247]
    v_mfma_f32_16x16x32_bf16 v[244:247], v[240:243], v[100:103], v[244:247]
    s_waitcnt vmcnt(10)
    s_barrier
    ds_read_b64_tr_b16 v[104:105], v237 offset:0
    ds_read_b64_tr_b16 v[106:107], v237 offset:512
    ds_read_b64_tr_b16 v[108:109], v237 offset:4096
    ds_read_b64_tr_b16 v[110:111], v237 offset:4608
    ds_read_b64_tr_b16 v[112:113], v237 offset:8192
    ds_read_b64_tr_b16 v[114:115], v237 offset:8704
    ds_read_b64_tr_b16 v[116:117], v237 offset:12288
    ds_read_b64_tr_b16 v[118:119], v237 offset:12800
    ds_read_b64_tr_b16 v[120:121], v237 offset:16384
    ds_read_b64_tr_b16 v[122:123], v237 offset:16896
    s_waitcnt lgkmcnt(0)
    s_barrier
    s_add_u32 m0, s67, 98304
    s_nop 0
    buffer_load_dwordx4 v4, s[44:47], s65 offen nt lds
    s_add_u32 s65, s65, 256
    s_add_u32 m0, s67, 106496
    s_nop 0
    buffer_load_dwordx4 v4, s[44:47], s65 offen nt lds
    s_add_u32 s65, s65, 256
    s_add_u32 m0, s67, 114688
    s_nop 0
    buffer_load_dwordx4 v4, s[44:47], s65 offen nt lds
    s_add_u32 s65, s65, 256
    s_add_u32 m0, s67, 122880
    s_nop 0
    buffer_load_dwordx4 v4, s[44:47], s65 offen nt lds
    s_add_u32 s65, s65, 256
    s_add_u32 m0, s67, 131072
    s_nop 0
    buffer_load_dwordx4 v4, s[44:47], s65 offen nt lds
    s_add_u32 s65, s65, 39936
    s_waitcnt lgkmcnt(0)
    v_mfma_f32_16x16x32_bf16 v[244:247], v[240:243], v[104:107], v[244:247]
    v_mfma_f32_16x16x32_bf16 v[244:247], v[240:243], v[108:111], v[244:247]
    v_mfma_f32_16x16x32_bf16 v[244:247], v[240:243], v[112:115], v[244:247]
    v_mfma_f32_16x16x32_bf16 v[244:247], v[240:243], v[116:119], v[244:247]
    v_mfma_f32_16x16x32_bf16 v[244:247], v[240:243], v[120:123], v[244:247]
    s_waitcnt vmcnt(10)
    s_barrier
    ds_read_b64_tr_b16 v[124:125], v7 offset:0
    ds_read_b64_tr_b16 v[126:127], v7 offset:512
    ds_read_b64_tr_b16 v[128:129], v7 offset:4096
    ds_read_b64_tr_b16 v[130:131], v7 offset:4608
    ds_read_b64_tr_b16 v[132:133], v7 offset:8192
    ds_read_b64_tr_b16 v[134:135], v7 offset:8704
    ds_read_b64_tr_b16 v[136:137], v7 offset:12288
    ds_read_b64_tr_b16 v[138:139], v7 offset:12800
    ds_read_b64_tr_b16 v[140:141], v7 offset:16384
    ds_read_b64_tr_b16 v[142:143], v7 offset:16896
    s_waitcnt lgkmcnt(0)
    v_mfma_f32_16x16x32_bf16 v[244:247], v[240:243], v[124:127], v[244:247]
    v_mfma_f32_16x16x32_bf16 v[244:247], v[240:243], v[128:131], v[244:247]
    v_mfma_f32_16x16x32_bf16 v[244:247], v[240:243], v[132:135], v[244:247]
    v_mfma_f32_16x16x32_bf16 v[244:247], v[240:243], v[136:139], v[244:247]
    v_mfma_f32_16x16x32_bf16 v[244:247], v[240:243], v[140:143], v[244:247]
    s_waitcnt vmcnt(5)
    s_barrier
    ds_read_b64_tr_b16 v[144:145], v232 offset:0
    ds_read_b64_tr_b16 v[146:147], v232 offset:1024
    ds_read_b64_tr_b16 v[152:153], v233 offset:0
    ds_read_b64_tr_b16 v[154:155], v233 offset:1024
    ds_read_b64_tr_b16 v[160:161], v234 offset:0
    ds_read_b64_tr_b16 v[162:163], v234 offset:1024
    ds_read_b64_tr_b16 v[168:169], v235 offset:0
    ds_read_b64_tr_b16 v[170:171], v235 offset:1024
    ds_read_b64_tr_b16 v[176:177], v236 offset:0
    ds_read_b64_tr_b16 v[178:179], v236 offset:1024
    s_waitcnt vmcnt(0)
    s_barrier
    ds_read_b64_tr_b16 v[148:149], v232 offset:40960
    ds_read_b64_tr_b16 v[150:151], v232 offset:41984
    ds_read_b64_tr_b16 v[156:157], v233 offset:40960
    ds_read_b64_tr_b16 v[158:159], v233 offset:41984
    ds_read_b64_tr_b16 v[164:165], v234 offset:40960
    ds_read_b64_tr_b16 v[166:167], v234 offset:41984
    ds_read_b64_tr_b16 v[172:173], v235 offset:40960
    ds_read_b64_tr_b16 v[174:175], v235 offset:41984
    ds_read_b64_tr_b16 v[180:181], v236 offset:40960
    ds_read_b64_tr_b16 v[182:183], v236 offset:41984
    v_mov_b32 v47, v244
    s_waitcnt lgkmcnt(0)
    s_branch L_F
L_R:
    s_cbranch_execz L_R_nodma
    s_mov_b32 s48, s24
    s_mov_b32 s49, s25
    s_mov_b32 s50, 5242880
    s_mov_b32 s51, 0x20000
    s_add_u32 s64, s9, 0
    s_lshl_b32 s67, s3, 10
    s_add_u32 m0, s67, 16384
    s_nop 0
    buffer_load_dwordx4 v21, s[48:51], s64 offen nt lds
    s_add_u32 s64, s64, 81920
    s_add_u32 m0, m0, 8192
    s_nop 0
    buffer_load_dwordx4 v21, s[48:51], s64 offen nt lds
    s_add_u32 s64, s64, 573440
    s_add_u32 m0, m0, 8192
    s_nop 0
    buffer_load_dwordx4 v21, s[48:51], s64 offen nt lds
    s_add_u32 s64, s64, 81920
    s_add_u32 m0, m0, 8192
    s_nop 0
    buffer_load_dwordx4 v21, s[48:51], s64 offen nt lds
    s_add_u32 s64, s64, 573440
    s_add_u32 m0, m0, 8192
    s_nop 0
    buffer_load_dwordx4 v21, s[48:51], s64 offen nt lds
    s_add_u32 s64, s64, 81920
    s_add_u32 m0, m0, 8192
    s_nop 0
    buffer_load_dwordx4 v21, s[48:51], s64 offen nt lds
    s_add_u32 s64, s64, 573440
    s_add_u32 m0, m0, 8192
    s_nop 0
    buffer_load_dwordx4 v21, s[48:51], s64 offen nt lds
    s_add_u32 s64, s64, 81920
    s_add_u32 m0, m0, 8192
    s_nop 0
    buffer_load_dwordx4 v21, s[48:51], s64 offen nt lds
    s_add_u32 s64, s64, 573440
    s_add_u32 m0, m0, 8192
    s_nop 0
    buffer_load_dwordx4 v21, s[48:51], s64 offen nt lds
    s_add_u32 s64, s64, 81920
    s_add_u32 m0, m0, 8192
    s_nop 0
    buffer_load_dwordx4 v21, s[48:51], s64 offen nt lds
    s_add_u32 s64, s64, 573440
    s_add_u32 m0, m0, 8192
    s_nop 0
    buffer_load_dwordx4 v21, s[48:51], s64 offen nt lds
    s_add_u32 s64, s64, 81920
    s_add_u32 m0, m0, 8192
    s_nop 0
    buffer_load_dwordx4 v21, s[48:51], s64 offen nt lds
    s_add_u32 s64, s64, 573440
    s_add_u32 m0, m0, 8192
    s_nop 0
    buffer_load_dwordx4 v21, s[48:51], s64 offen nt lds
    s_add_u32 s64, s64, 81920
    s_add_u32 m0, m0, 8192
    s_nop 0
    buffer_load_dwordx4 v21, s[48:51], s64 offen nt lds
    s_add_u32 s64, s64, 573440
    s_add_u32 m0, m0, 8192
    s_nop 0
    buffer_load_dwordx4 v21, s[48:51], s64 offen nt lds
    s_add_u32 s64, s64, 81920
    s_add_u32 m0, m0, 8192
    s_nop 0
    buffer_load_dwordx4 v21, s[48:51], s64 offen nt lds
    s_add_u32 s64, s64, 573440
    s_add_u32 m0, m0, 8192
L_R_nodma:
    s_mov_b32 s69, 0x3fb8aa3b
    v_cmp_gt_u32 s[74:75], 2, v3
    s_cbranch_execz L_vm6
    buffer_load_dwordx4 v[156:159], v17, s[40:43], s6 offen offset:0 sc1
    buffer_load_dwordx4 v[160:163], v17, s[40:43], s6 offen offset:16 sc1
    buffer_load_dwordx4 v[164:167], v17, s[40:43], s6 offen offset:32 sc1
L_vm6:
    s_waitcnt vmcnt(0)
    s_cbranch_execz L_nb2
    s_barrier
L_nb2:
    ds_read_b64_tr_b16 v[192:193], v22 offset:0
    ds_read_b64_tr_b16 v[194:195], v22 offset:512
    ds_read_b64_tr_b16 v[196:197], v22 offset:4096
    ds_read_b64_tr_b16 v[198:199], v22 offset:4608
    ds_read_b64_tr_b16 v[200:201], v22 offset:8192
    ds_read_b64_tr_b16 v[202:203], v22 offset:8704
    ds_read_b64_tr_b16 v[204:205], v22 offset:12288
    ds_read_b64_tr_b16 v[206:207], v22 offset:12800
    ds_read_b64_tr_b16 v[208:209], v22 offset:16384
    ds_read_b64_tr_b16 v[210:211], v22 offset:16896
    ds_read_b64_tr_b16 v[212:213], v22 offset:20480
    ds_read_b64_tr_b16 v[214:215], v22 offset:20992
    ds_read_b64_tr_b16 v[216:217], v22 offset:24576
    ds_read_b64_tr_b16 v[218:219], v22 offset:25088
    ds_read_b64_tr_b16 v[220:221], v22 offset:28672
    ds_read_b64_tr_b16 v[222:223], v22 offset:29184
    ds_read_b64_tr_b16 v[224:225], v22 offset:32768
    ds_read_b64_tr_b16 v[226:227], v22 offset:33280
    ds_read_b64_tr_b16 v[228:229], v22 offset:36864
    ds_read_b64_tr_b16 v[230:231], v22 offset:37376
    ds_read_b64_tr_b16 v[232:233], v22 offset:40960
    ds_read_b64_tr_b16 v[234:235], v22 offset:41472
    ds_read_b64_tr_b16 v[236:237], v22 offset:45056
    ds_read_b64_tr_b16 v[238:239], v22 offset:45568
    ds_read_b64_tr_b16 v[240:241], v22 offset:49152
    ds_read_b64_tr_b16 v[242:243], v22 offset:49664
    ds_read_b64_tr_b16 v[244:245], v22 offset:53248
    ds_read_b64_tr_b16 v[246:247], v22 offset:53760
    ds_read_b64_tr_b16 v[248:249], v22 offset:57344
    ds_read_b64_tr_b16 v[250:251], v22 offset:57856
    ds_read_b64_tr_b16 v[252:253], v22 offset:61440
    ds_read_b64_tr_b16 v[254:255], v22 offset:61952
    v_bitop3_b32 v32, v157, v159, s12 bitop3:0x7e
    v_bitop3_b32 v33, v161, v163, s12 bitop3:0x7e
    v_bitop3_b32 v34, v165, v167, s12 bitop3:0x7e
    v_or3_b32 v32, v32, v33, v34
    v_cmp_ne_u32 vcc, 0, v32
    s_cbranch_vccz L_R_stok
    s_mov_b32 s82, 400000
    s_branch L_R_pst_e
L_R_pst:
    s_sleep 2
L_R_pst_e:
    s_cbranch_execz L_vm7
    buffer_load_dwordx4 v[156:159], v17, s[40:43], s6 offen offset:0 sc1
    buffer_load_dwordx4 v[160:163], v17, s[40:43], s6 offen offset:16 sc1
    buffer_load_dwordx4 v[164:167], v17, s[40:43], s6 offen offset:32 sc1
L_vm7:
    s_sub_u32 s82, s82, 1
    s_cmp_eq_u32 s82, 0
    s_cselect_b64 s[76:77], 0, -1
    s_waitcnt vmcnt(0)
    v_bitop3_b32 v32, v157, v159, s12 bitop3:0x7e
    v_bitop3_b32 v33, v161, v163, s12 bitop3:0x7e
    v_bitop3_b32 v34, v165, v167, s12 bitop3:0x7e
    v_or3_b32 v32, v32, v33, v34
    v_cmp_ne_u32 vcc, 0, v32
    s_nop 0
    s_and_b64 vcc, vcc, s[76:77]
    s_cbranch_vccnz L_R_pst
L_R_stok:
    v_max3_f32 v32, v156, v160, v164
    v_sub_f32 v24, v156, v32
    v_sub_f32 v26, v160, v32
    v_sub_f32 v28, v164, v32
    v_mul_f32 v24, s69, v24
    v_mul_f32 v26, s69, v26
    v_mul_f32 v28, s69, v28
    v_exp_f32 v24, v24
    v_exp_f32 v26, v26
    v_exp_f32 v28, v28
    v_mul_f32 v32, v24, v158
    v_fmac_f32 v32, v26, v162
    v_fmac_f32 v32, v28, v166
    v_rcp_f32 v32, v32
    s_nop 0
    v_mul_f32 v24, v24, v32
    v_mul_f32 v26, v26, v32
    v_mul_f32 v28, v28, v32
    v_mov_b32 v168, 0
    v_mov_b32 v169, 0
    v_mov_b32 v170, 0
    v_mov_b32 v171, 0
    v_mov_b32 v172, 0
    v_mov_b32 v173, 0
    v_mov_b32 v174, 0
    v_mov_b32 v175, 0
    v_mov_b32 v176, 0
    v_mov_b32 v177, 0
    v_mov_b32 v178, 0
    v_mov_b32 v179, 0
    v_mov_b32 v180, 0
    v_mov_b32 v181, 0
    v_mov_b32 v182, 0
    v_mov_b32 v183, 0
    s_mov_b32 s67, 0
    s_mov_b32 s68, -16
    s_mov_b32 s82, 1600000
    s_cmp_lg_u32 s83, 0
    s_cselect_b32 s82, 2, s82
L_R_loop:
    s_cmp_lg_u32 s67, 0
    s_cbranch_scc1 L_R_chk
    s_sleep 1
    s_cbranch_execz L_vm8
    buffer_load_dwordx4 v[148:151], v16, s[40:43], s5 offen offset:0 sc1
    buffer_load_dwordx4 v[152:155], v16, s[40:43], s5 offen offset:512 sc1
    buffer_load_dwordx4 v[184:187], v16, s[40:43], s5 offen offset:1024 sc1
L_vm8:
L_R_chk:
    ds_read_b32 v25, v55 offset:14016
    s_sub_u32 s82, s82, 1
    s_waitcnt lgkmcnt(0)
    v_readfirstlane_b32 s69, v25
    s_nop 0
    s_lshr_b32 s69, s69, s61
    s_cmp_eq_u32 s82, 0
    s_cselect_b32 s69, 15, s69
    s_andn2_b32 s69, s69, s68
    s_cbranch_scc0 L_R_own
    s_or_b32 s68, s68, s69
    s_bitcmp1_b32 s69, 0
    s_cbranch_scc0 L_R_h0
    ds_read_b128 v[132:135], v19 offset:4352
    s_waitcnt lgkmcnt(0)
    v_smfmac_f32_16x16x64_bf16 v[168:171], v[132:135], v[192:199], v15
    v_smfmac_f32_16x16x64_bf16 v[172:175], v[132:135], v[200:207], v15
    s_cmp_eq_u32 s8, 0
    s_cbranch_scc1 L_R_h0
    v_smfmac_f32_16x16x64_bf16 v[176:179], v[132:135], v[64:71], v15
    v_smfmac_f32_16x16x64_bf16 v[180:183], v[132:135], v[72:79], v15
L_R_h0:
    s_bitcmp1_b32 s69, 1
    s_cbranch_scc0 L_R_h1
    ds_read_b128 v[136:139], v19 offset:4608
    s_waitcnt lgkmcnt(0)
    v_smfmac_f32_16x16x64_bf16 v[168:171], v[136:139], v[208:215], v15
    v_smfmac_f32_16x16x64_bf16 v[172:175], v[136:139], v[216:223], v15
    s_cmp_eq_u32 s8, 0
    s_cbranch_scc1 L_R_h1
    v_smfmac_f32_16x16x64_bf16 v[176:179], v[136:139], v[80:87], v15
    v_smfmac_f32_16x16x64_bf16 v[180:183], v[136:139], v[88:95], v15
L_R_h1:
    s_bitcmp1_b32 s69, 2
    s_cbranch_scc0 L_R_h2
    ds_read_b128 v[140:143], v19 offset:4864
    s_waitcnt lgkmcnt(0)
    v_smfmac_f32_16x16x64_bf16 v[168:171], v[140:143], v[224:231], v15
    v_smfmac_f32_16x16x64_bf16 v[172:175], v[140:143], v[232:239], v15
    s_cmp_eq_u32 s8, 0
    s_cbranch_scc1 L_R_h2
    v_smfmac_f32_16x16x64_bf16 v[176:179], v[140:143], v[96:103], v15
    v_smfmac_f32_16x16x64_bf16 v[180:183], v[140:143], v[104:111], v15
L_R_h2:
    s_bitcmp1_b32 s69, 3
    s_cbranch_scc0 L_R_h3
    ds_read_b128 v[144:147], v19 offset:5120
    s_waitcnt lgkmcnt(0)
    v_smfmac_f32_16x16x64_bf16 v[168:171], v[144:147], v[240:247], v15
    v_smfmac_f32_16x16x64_bf16 v[172:175], v[144:147], v[248:255], v15
    s_cmp_eq_u32 s8, 0
    s_cbranch_scc1 L_R_h3
    v_smfmac_f32_16x16x64_bf16 v[176:179], v[144:147], v[112:119], v15
    v_smfmac_f32_16x16x64_bf16 v[180:183], v[144:147], v[120:127], v15
L_R_h3:
    s_cmp_eq_u32 s68, -1
    s_cbranch_scc1 L_R_fin
L_R_own:
    s_cmp_lg_u32 s67, 0
    s_cbranch_scc1 L_R_chk
    s_waitcnt vmcnt(2)
    v_xor_b32 v148, s60, v148
    v_xor_b32 v149, s60, v149
    v_xor_b32 v150, s60, v150
    v_xor_b32 v151, s60, v151
    v_pk_mul_f32 v[32:33], v[148:149], v[24:25] op_sel_hi:[1,0]
    v_pk_mul_f32 v[34:35], v[150:151], v[24:25] op_sel_hi:[1,0]
    v_or_b32 v156, v148, v149
    v_or3_b32 v156, v156, v150, v151
    s_waitcnt vmcnt(1)
    v_xor_b32 v152, s60, v152
    v_xor_b32 v153, s60, v153
    v_xor_b32 v154, s60, v154
    v_xor_b32 v155, s60, v155
    v_pk_fma_f32 v[32:33], v[152:153], v[26:27], v[32:33] op_sel_hi:[1,0,1]
    v_pk_fma_f32 v[34:35], v[154:155], v[26:27], v[34:35] op_sel_hi:[1,0,1]
    v_or3_b32 v156, v156, v152, v153
    v_or3_b32 v156, v156, v154, v155
    s_waitcnt vmcnt(0)
    v_xor_b32 v184, s60, v184
    v_xor_b32 v185, s60, v185
    v_xor_b32 v186, s60, v186
    v_xor_b32 v187, s60, v187
    v_pk_fma_f32 v[32:33], v[184:185], v[28:29], v[32:33] op_sel_hi:[1,0,1]
    v_pk_fma_f32 v[34:35], v[186:187], v[28:29], v[34:35] op_sel_hi:[1,0,1]
    v_or3_b32 v156, v156, v184, v185
    v_or3_b32 v156, v156, v186, v187
    v_cmp_ne_u32_sdwa vcc, v156, 0 src0_sel:BYTE_0 src1_sel:DWORD
    v_cvt_pk_bf16_f32 v32, v32, v33
    v_cvt_pk_bf16_f32 v34, v34, v35
    s_cmp_lt_u32 s82, 64
    s_cselect_b64 s[76:77], 0, -1
    s_and_b64 vcc, vcc, s[76:77]
    s_cbranch_vccnz L_R_loop
    ds_write2_b32 v18, v32, v34 offset0:0 offset1:32
    s_and_b64 exec, s[78:79], 1
    ds_or_b32 v55, v52 offset:14016
    s_mov_b64 exec, s[78:79]
    s_mov_b32 s67, 1
    s_branch L_R_chk
L_R_fin:
    s_nop 3
    v_add_f32 v168, v168, v169
    v_add_f32 v172, v172, v173
    s_nop 1
    v_permlane32_swap_b32 v172, v170
    v_add_f32 v168, v168, v170
    s_and_b64 exec, s[78:79], 0xffffffff
    ds_wrxchg_rtn_b32 v169, v20, v168 offset:9600
    s_waitcnt lgkmcnt(0)
    v_cmp_ne_u32 vcc, -1, v169
    v_add_f32 v168, v168, v169
    v_bfi_b32 v168, v63, s12, v168
    s_and_b64 exec, exec, vcc
    s_cbranch_execz L_vm9
    buffer_store_dword v168, v58, s[40:43], s4 offen offset:0 sc1
L_vm9:
    s_mov_b64 exec, s[78:79]
    s_cmp_eq_u32 s8, 0
    s_cbranch_scc1 L_R_x
    v_add_f32 v176, v176, v177
    v_add_f32 v180, v180, v181
    s_nop 1
    v_permlane32_swap_b32 v180, v178
    v_add_f32 v176, v176, v178
    s_and_b64 exec, s[78:79], 0xffffffff
    ds_wrxchg_rtn_b32 v177, v20, v176 offset:10112
    s_waitcnt lgkmcnt(0)
    v_cmp_ne_u32 vcc, -1, v177
    v_add_f32 v176, v176, v177
    v_bfi_b32 v176, v63, s12, v176
    s_and_b64 exec, exec, vcc
    s_cbranch_execz L_vm10
    buffer_store_dword v176, v58, s[40:43], s4 offen offset:512 sc1
L_vm10:
    s_mov_b64 exec, s[78:79]
L_R_x:
    s_mov_b64 exec, s[78:79]
    s_branch L_end
L_F:
    s_mov_b32 s69, 0x3f803f80
    v_cmp_gt_u32 s[72:73], 40, v1
    v_mov_b32 v16, 0
    v_mov_b32 v17, 0
    v_mov_b32 v18, 0
    v_mov_b32 v19, 0
    v_mov_b32 v20, 0
    v_mov_b32 v21, 0
    v_mov_b32 v22, 0
    v_mov_b32 v23, 0
    v_mov_b32 v232, 0
    v_mov_b32 v233, 0
    v_mov_b32 v234, 0
    v_mov_b32 v235, 0
    v_mov_b32 v236, 0
    v_mov_b32 v237, 0
    v_mov_b32 v238, 0
    v_mov_b32 v239, 0
    v_mov_b32 v240, 0
    v_mov_b32 v241, 0
    v_mov_b32 v242, 0
    v_mov_b32 v243, 0
    v_mov_b32 v244, 0
    v_mov_b32 v245, 0
    v_mov_b32 v246, 0
    v_mov_b32 v247, 0
    v_mov_b32 v248, 0
    v_mov_b32 v249, 0
    v_mov_b32 v250, 0
    v_mov_b32 v251, 0
    s_and_b64 exec, s[78:79], s[72:73]
    v_mov_b32 v216, 0
    v_mov_b32 v217, 0
    v_mov_b32 v218, 0
    v_mov_b32 v219, 0
    s_mov_b32 s67, 0
    s_mov_b32 s82, 400000
L_F_poll:
    s_sleep 1
    s_bitcmp1_b32 s67, 0
    s_cbranch_scc1 L_F_i0
    s_cbranch_execz L_vm11
    buffer_load_dwordx4 v[184:187], v10, s[40:43], s90 offen sc1
L_vm11:
L_F_i0:
    s_bitcmp1_b32 s67, 1
    s_cbranch_scc1 L_F_i1
    s_cbranch_execz L_vm12
    buffer_load_dwordx4 v[188:191], v10, s[40:43], s91 offen sc1
L_vm12:
L_F_i1:
    s_bitcmp1_b32 s67, 2
    s_cbranch_scc1 L_F_i2
    s_cbranch_execz L_vm13
    buffer_load_dwordx4 v[192:195], v10, s[40:43], s92 offen sc1
L_vm13:
L_F_i2:
    s_bitcmp1_b32 s67, 3
    s_cbranch_scc1 L_F_i3
    s_cbranch_execz L_vm14
    buffer_load_dwordx4 v[196:199], v10, s[40:43], s93 offen sc1
L_vm14:
L_F_i3:
    s_sub_u32 s82, s82, 1
    s_cmp_eq_u32 s82, 0
    s_cselect_b64 s[76:77], 0, -1
    s_waitcnt vmcnt(0)
L_F_c0:
    s_bitcmp1_b32 s67, 0
    s_cbranch_scc1 L_F_c1
    v_xor_b32 v184, s60, v184
    v_xor_b32 v185, s60, v185
    v_xor_b32 v186, s60, v186
    v_xor_b32 v187, s60, v187
    v_or3_b32 v220, v184, v185, v186
    v_or_b32 v220, v220, v187
    v_cmp_ne_u32_sdwa vcc, v220, 0 src0_sel:BYTE_0 src1_sel:DWORD
    s_nop 0
    s_and_b64 vcc, vcc, s[76:77]
    s_cbranch_vccnz L_F_c1
    v_pk_add_f32 v[216:217], v[216:217], v[184:185]
    v_pk_add_f32 v[218:219], v[218:219], v[186:187]
    s_bitset1_b32 s67, 0
    s_cmp_eq_u32 s67, 15
    s_cbranch_scc1 L_F_got
L_F_c1:
    s_bitcmp1_b32 s67, 1
    s_cbranch_scc1 L_F_c2
    v_xor_b32 v188, s60, v188
    v_xor_b32 v189, s60, v189
    v_xor_b32 v190, s60, v190
    v_xor_b32 v191, s60, v191
    v_or3_b32 v220, v188, v189, v190
    v_or_b32 v220, v220, v191
    v_cmp_ne_u32_sdwa vcc, v220, 0 src0_sel:BYTE_0 src1_sel:DWORD
    s_nop 0
    s_and_b64 vcc, vcc, s[76:77]
    s_cbranch_vccnz L_F_c2
    v_pk_add_f32 v[216:217], v[216:217], v[188:189]
    v_pk_add_f32 v[218:219], v[218:219], v[190:191]
    s_bitset1_b32 s67, 1
    s_cmp_eq_u32 s67, 15
    s_cbranch_scc1 L_F_got
L_F_c2:
    s_bitcmp1_b32 s67, 2
    s_cbranch_scc1 L_F_c3
    v_xor_b32 v192, s60, v192
    v_xor_b32 v193, s60, v193
    v_xor_b32 v194, s60, v194
    v_xor_b32 v195, s60, v195
    v_or3_b32 v220, v192, v193, v194
    v_or_b32 v220, v220, v195
    v_cmp_ne_u32_sdwa vcc, v220, 0 src0_sel:BYTE_0 src1_sel:DWORD
    s_nop 0
    s_and_b64 vcc, vcc, s[76:77]
    s_cbranch_vccnz L_F_c3
    v_pk_add_f32 v[216:217], v[216:217], v[192:193]
    v_pk_add_f32 v[218:219], v[218:219], v[194:195]
    s_bitset1_b32 s67, 2
    s_cmp_eq_u32 s67, 15
    s_cbranch_scc1 L_F_got
L_F_c3:
    s_bitcmp1_b32 s67, 3
    s_cbranch_scc1 L_F_c4
    v_xor_b32 v196, s60, v196
    v_xor_b32 v197, s60, v197
    v_xor_b32 v198, s60, v198
    v_xor_b32 v199, s60, v199
    v_or3_b32 v220, v196, v197, v198
    v_or_b32 v220, v220, v199
    v_cmp_ne_u32_sdwa vcc, v220, 0 src0_sel:BYTE_0 src1_sel:DWORD
    s_nop 0
    s_and_b64 vcc, vcc, s[76:77]
    s_cbranch_vccnz L_F_c4
    v_pk_add_f32 v[216:217], v[216:217], v[196:197]
    v_pk_add_f32 v[218:219], v[218:219], v[198:199]
    s_bitset1_b32 s67, 3
    s_cmp_eq_u32 s67, 15
    s_cbranch_scc1 L_F_got
L_F_c4:
    s_branch L_F_poll
L_F_got:
    v_cvt_pk_bf16_f32 v226, v216, v217
    v_cvt_pk_bf16_f32 v227, v218, v219
L_F_got2:
    v_and_b32 v185, 0xffff0000, v226
    v_lshlrev_b32 v184, 16, v226
    v_and_b32 v187, 0xffff0000, v227
    v_lshlrev_b32 v186, 16, v227
    v_pk_add_f32 v[184:185], v[184:185], v[48:49]
    v_pk_add_f32 v[186:187], v[186:187], v[50:51]
    v_cvt_pk_bf16_f32 v184, v184, v185
    v_cvt_pk_bf16_f32 v185, v186, v187
    ds_write2_b32 v9, v184, v185 offset0:0 offset1:160
    v_dot2_f32_bf16 v186, v184, s69, 0
    v_dot2_f32_bf16 v187, v184, v184, 0
    v_dot2_f32_bf16 v186, v185, s69, v186
    v_dot2_f32_bf16 v187, v185, v185, v187
    s_nop 1
    v_add_f32_dpp v186, v186, v186 quad_perm:[1,0,3,2] row_mask:0xf bank_mask:0xf
    v_add_f32_dpp v187, v187, v187 quad_perm:[1,0,3,2] row_mask:0xf bank_mask:0xf
    s_nop 0
    v_add_f32_dpp v186, v186, v186 quad_perm:[2,3,0,1] row_mask:0xf bank_mask:0xf
    v_add_f32_dpp v187, v187, v187 quad_perm:[2,3,0,1] row_mask:0xf bank_mask:0xf
    ds_write_b64 v8, v[186:187] offset:11008
    s_mov_b64 exec, s[78:79]
    s_waitcnt lgkmcnt(0)
    s_cbranch_execz L_nb3
    s_barrier
L_nb3:
    ds_read2_b64 v[204:207], v12 offset0:0 offset1:32
    ds_read_b128 v[184:187], v11 offset:6912
    ds_read_b128 v[188:191], v11 offset:6976
    ds_read_b128 v[192:195], v11 offset:7040
    ds_read_b128 v[196:199], v11 offset:7104
    ds_read_b128 v[200:203], v11 offset:7168
    s_waitcnt lgkmcnt(5)
    v_pk_add_f32 v[36:37], v[204:205], v[206:207]
    s_waitcnt lgkmcnt(4)
    v_smfmac_f32_16x16x64_bf16 v[16:19], v[184:187], v[64:71], v15
    v_permlane32_swap_b32 v36, v37
    v_add_f32 v36, v36, v37
    v_smfmac_f32_16x16x64_bf16 v[20:23], v[184:187], v[104:111], v15
    s_nop 0
    v_add_f32_dpp v36, v36, v36 quad_perm:[1,0,3,2] row_mask:0xf bank_mask:0xf
    s_waitcnt lgkmcnt(3)
    v_smfmac_f32_16x16x64_bf16 v[16:19], v[188:191], v[72:79], v15
    v_add_f32_dpp v36, v36, v36 quad_perm:[2,3,0,1] row_mask:0xf bank_mask:0xf
    v_smfmac_f32_16x16x64_bf16 v[20:23], v[188:191], v[112:119], v15
    s_nop 0
    v_add_f32_dpp v36, v36, v36 row_half_mirror row_mask:0xf bank_mask:0xf
    s_waitcnt lgkmcnt(2)
    v_smfmac_f32_16x16x64_bf16 v[16:19], v[192:195], v[80:87], v15
    v_add_f32_dpp v36, v36, v36 row_mirror row_mask:0xf bank_mask:0xf
    v_mul_f32 v36, 0x3acccccd, v36
    v_mov_b32 v37, v36
    v_smfmac_f32_16x16x64_bf16 v[20:23], v[192:195], v[120:127], v15
    s_nop 0
    v_permlane32_swap_b32 v36, v37
    v_fma_f32 v37, -v36, v36, v37
    v_max_f32 v37, 0, v37
    v_cvt_pk_bf16_f32 v37, v37, v37
    s_waitcnt lgkmcnt(1)
    v_smfmac_f32_16x16x64_bf16 v[16:19], v[196:199], v[88:95], v15
    v_and_b32 v37, 0xffff0000, v37
    v_add_f32 v37, 0x3727c5ac, v37
    v_cvt_pk_bf16_f32 v37, v37, v37
    v_and_b32 v37, 0xffff0000, v37
    v_smfmac_f32_16x16x64_bf16 v[20:23], v[196:199], v[128:135], v15
    v_sqrt_f32 v37, v37
    v_cvt_pk_bf16_f32 v36, v36, v36
    v_and_b32 v36, 0xffff0000, v36
    v_cvt_pk_bf16_f32 v37, v37, v37
    s_waitcnt lgkmcnt(0)
    v_smfmac_f32_16x16x64_bf16 v[16:19], v[200:203], v[96:103], v15
    v_and_b32 v37, 0xffff0000, v37
    v_rcp_f32 v38, v37
    v_mul_f32 v36, v36, v47
    v_smfmac_f32_16x16x64_bf16 v[20:23], v[200:203], v[136:143], v15
    s_nop 7
    v_add_f32 v20, v20, v21
    v_sub_f32 v28, v16, v36
    v_add_f32 v28, v28, v17
    v_permlane32_swap_b32 v20, v18
    v_add_f32 v28, v28, v18
    v_mul_f32 v28, v28, v38
    v_cvt_pk_bf16_f32 v28, v28, v28
    v_and_b32 v28, 0xffff0000, v28
    v_mul_f32 v30, v28, v28
    v_mov_b32 v31, 0xc0135761
    v_fmac_f32 v31, 0xbdd2d3e8, v30
    v_mul_f32 v30, v31, v28
    v_exp_f32 v30, v30
    s_nop 0
    v_add_f32 v30, 1.0, v30
    v_rcp_f32 v30, v30
    s_nop 0
    v_mul_f32 v30, v28, v30
    v_cvt_pk_bf16_f32 v30, v30, v30
    v_and_b32 v30, 0xffff0000, v30
    v_mul_f32_dpp v30, v28, v30 row_ror:8 row_mask:0xf bank_mask:0xf
    v_cvt_pk_bf16_f32 v30, v30, v30
    s_and_b64 exec, s[78:79], 0x00ff00ff
    ds_write_b16 v13, v30 offset:13568
    s_mov_b64 exec, s[78:79]
    s_waitcnt lgkmcnt(0)
L_F_b2:
    s_cbranch_execz L_nb4
    s_barrier
L_nb4:
    ds_read_b128 v[184:187], v42 offset:13568
    s_waitcnt lgkmcnt(0)
    v_smfmac_f32_16x16x64_bf16 v[248:251], v[184:187], v[176:183], v46
    v_smfmac_f32_16x16x64_bf16 v[232:235], v[184:187], v[144:151], v46
    v_smfmac_f32_16x16x64_bf16 v[236:239], v[184:187], v[152:159], v46
    v_smfmac_f32_16x16x64_bf16 v[240:243], v[184:187], v[160:167], v46
    v_smfmac_f32_16x16x64_bf16 v[244:247], v[184:187], v[168:175], v46
    s_nop 3
    v_pk_add_f32 v[248:249], v[248:249], v[250:251]
    v_pk_add_f32 v[16:17], v[232:233], v[234:235]
    v_bfi_b32 v248, v63, s12, v248
    v_bfi_b32 v249, v63, s12, v249
    v_add_f32_dpp v16, v236, v238 quad_perm:[0,1,2,3] row_mask:0x2 bank_mask:0xf
    v_add_f32_dpp v17, v237, v239 quad_perm:[0,1,2,3] row_mask:0x2 bank_mask:0xf
    v_add_f32_dpp v16, v240, v242 quad_perm:[0,1,2,3] row_mask:0x4 bank_mask:0xf
    v_add_f32_dpp v17, v241, v243 quad_perm:[0,1,2,3] row_mask:0x4 bank_mask:0xf
    s_and_b64 exec, s[78:79], 0xffff
    s_cbranch_execz L_vm15
    buffer_store_dwordx2 v[248:249], v54, s[40:43], s98 offen offset:512 sc1
L_vm15:
    s_mov_b64 exec, s[78:79]
    v_add_f32_dpp v16, v244, v246 quad_perm:[0,1,2,3] row_mask:0x8 bank_mask:0xf
    v_add_f32_dpp v17, v245, v247 quad_perm:[0,1,2,3] row_mask:0x8 bank_mask:0xf
    v_bfi_b32 v16, v63, s12, v16
    v_bfi_b32 v17, v63, s12, v17
    s_cbranch_execz L_vm16
    buffer_store_dwordx2 v[16:17], v54, s[40:43], s98 offen sc1
L_vm16:
    s_cmp_lg_u32 s80, 0
    s_cbranch_scc1 L_F_x
    s_cmp_lg_u32 s3, 4
    s_cbranch_scc1 L_F_x
    s_and_b64 exec, s[78:79], 1
    v_mov_b32 v184, s12
    s_mov_b32 s66, 360448
    s_cbranch_execz L_vm17
    buffer_store_dword v184, v55, s[40:43], s66 offen sc1
L_vm17:
L_F_x:
    s_mov_b64 exec, s[78:79]
L_end:
    s_cmp_eq_u32 s83, 0
    s_cbranch_scc1 L_exit
    s_mov_b32 s83, 0
    s_mov_b64 s[78:79], -1
    s_mov_b64 exec, -1
    s_waitcnt vmcnt(0) lgkmcnt(0)
    s_branch L_s_tail
L_exit:
    s_endpgm
.section .rodata,"a"
.p2align 6
.amdhsa_kernel sequential_preLN__gqa_block_cached__geglu_ffn__decode_kernel
  .amdhsa_next_free_vgpr 256
  .amdhsa_next_free_sgpr 102
  .amdhsa_accum_offset 256
  .amdhsa_group_segment_fixed_size 0
  .amdhsa_kernarg_size 96
  .amdhsa_user_sgpr_count 2
  .amdhsa_user_sgpr_kernarg_segment_ptr 1
  .amdhsa_system_sgpr_workgroup_id_x 1
  .amdhsa_float_denorm_mode_32 3
.end_amdhsa_kernel
```
